```python
import torch

def _softmax(x, axis=-1):
    return torch.softmax(x, dim=axis)
def _gelu(x):
    return torch.nn.functional.gelu(x, approximate="tanh")
def _silu(x):
    return torch.nn.functional.silu(x)
def _sigmoid(x):
    return torch.sigmoid(x)
def _layernorm(x, axis=-1, eps=1e-5):
    m = x.mean(dim=axis, keepdim=True)
    v = x.var(dim=axis, keepdim=True, unbiased=False)
    return (x - m) / torch.sqrt(v + eps)
def _scatter_add(tgt, idx, src, axis=0):
    return tgt.clone().index_add_(axis, idx, src)
def _segment_sum(src, seg, n):
    out = torch.zeros((n,) + src.shape[1:], dtype=src.dtype)
    return out.index_add_(0, seg, src)
def _pad(x, pw):
    flat = tuple(v for pair in reversed(pw) for v in pair)
    return torch.nn.functional.pad(x, flat)

kernel_name = 'gated_mix__ssm_conv_s4d__mixer_token_mlp__prompt'

def setup_inputs():

    _w = (lambda a: (lambda t: t.to(torch.bfloat16) if t.is_floating_point() else t)(torch.as_tensor(a)))
    def _A_setup():
        Bsz, L, D, N = 1, 2048, 576, 128
        return {
            "u": _w((lambda *s: torch.randn(*s, dtype=torch.bfloat16) * 0.05)(Bsz, L, D)),
            "log_A_real": _w((lambda *s: torch.randn(*s, dtype=torch.bfloat16) * 3.2)(D, N) * 0.5),
            "A_imag": _w((lambda *s: torch.randn(*s, dtype=torch.bfloat16) * 0.05)(D, N) * 3.14),
            "C_real": _w((lambda *s: torch.randn(*s, dtype=torch.bfloat16) * 0.1)(D, N) / N ** 0.5),
            "C_imag": _w((lambda *s: torch.randn(*s, dtype=torch.bfloat16) * 0.1)(D, N) / N ** 0.5),
            "log_dt": _w((lambda *s: torch.randn(*s, dtype=torch.bfloat16) * 0.05)(D) * 0.5 - 4.0),
            "D_skip": _w((lambda *s: torch.randn(*s, dtype=torch.bfloat16) * 0.05)(D)),
        }
    _A_in = _A_setup()

    def _B_setup():
        B, S, D, F = 1, 2048, 576, 4608
        return {
            "x": _w((lambda *s: torch.randn(*s, dtype=torch.bfloat16) * 0.05)(B, S, D)),
            "w1": _w((lambda *s: torch.randn(*s, dtype=torch.bfloat16) * 0.2)(S, F) * (S ** -0.5)),
            "b1": _w((lambda *s: torch.randn(*s, dtype=torch.bfloat16) * 3.2)(F) * 0.02),
            "w2": _w((lambda *s: torch.randn(*s, dtype=torch.bfloat16) * 0.05)(F, S) * (F ** -0.5)),
            "b2": _w((lambda *s: torch.randn(*s, dtype=torch.bfloat16) * 0.1)(S) * 0.02),
        }
    _B_in = _B_setup()

    return {
        "A_u": _A_in["u"],
        "A_log_A_real": _A_in["log_A_real"],
        "A_A_imag": _A_in["A_imag"],
        "A_C_real": _A_in["C_real"],
        "A_C_imag": _A_in["C_imag"],
        "A_log_dt": _A_in["log_dt"],
        "A_D_skip": _A_in["D_skip"],
        "B_x": _B_in["x"],
        "B_w1": _B_in["w1"],
        "B_b1": _B_in["b1"],
        "B_w2": _B_in["w2"],
        "B_b2": _B_in["b2"],
        "gate_w": _w((lambda *s: torch.randn(*s, dtype=torch.bfloat16) * 0.05)(576) * 16.0),
    }

def reference(A_u, A_log_A_real, A_A_imag, A_C_real, A_C_imag, A_log_dt, A_D_skip, B_x, B_w1, B_b1, B_w2, B_b2, gate_w):
    def _A_ref(u, log_A_real, A_imag, C_real, C_imag, log_dt, D_skip):
        L = u.shape[1]
        dt = torch.exp(log_dt)
        A = -torch.exp(log_A_real) + 1j * A_imag
        C = (C_real + 1j * C_imag) * dt[:, None]
        pos = (lambda x, dt: x.to(dt))(torch.arange(L), log_dt.dtype)
        P = torch.exp((A * dt[:, None])[:, :, None] * pos[None, None, :])
        K = 2.0 * torch.einsum("dn,dnl->dl", C, P).real
        L2 = 2 * L
        u_t = (lambda x, *d: x.permute(*d))(u, 0, 2, 1)
        Kf = (lambda x, *a, **k: torch.fft.rfft(x.float(), *a, **k))(K, L2)
        Uf = (lambda x, *a, **k: torch.fft.rfft(x.float(), *a, **k))(u_t, L2)
        y = (lambda x, *a, **k: torch.fft.irfft(x, *a, **k).to(torch.bfloat16))(Uf * Kf[None, :, :], L2)[:, :, :L]
        y = (lambda x, *d: x.permute(*d))(y, 0, 2, 1)
        return y + u * D_skip[None, None, :]

    def _B_ref(x, w1, b1, w2, b2):
        B, S, D = x.shape
        h = _layernorm(x, axis=-1)
        u = torch.einsum("bsd,sf->bdf", h, w1) + b1
        u = _gelu(u)
        y = torch.einsum("bdf,fs->bds", u, w2) + b2
        return (lambda x, *d: x.permute(*d))(y, 0, 2, 1)

    x = A_u
    g = _sigmoid((x * gate_w).sum(-1, keepdims=True))
    a = _A_ref(x, A_log_A_real, A_A_imag, A_C_real, A_C_imag, A_log_dt, A_D_skip)
    b = _B_ref(x, B_w1, B_b1, B_w2, B_b2)
    return g * a + (1 - g) * b
```

```asm
; @launch kernel=prep_kernel grid=(256,1,1) block=(256,1,1) lds=18688
; @launch kernel=mix_kernel grid=(504,1,1) block=(256,1,1) lds=73728
; @launch kernel=gemm2_kernel grid=(192,1,1) block=(256,1,1) lds=163840
.amdgcn_target "amdgcn-amd-amdhsa--gfx950"
.text
.globl prep_kernel
.p2align 8
.type prep_kernel,@function
prep_kernel:
    s_cmp_ge_u32 s2, 256
    s_cbranch_scc1 L_k0_done
    s_load_dwordx2 s[4:5], s[0:1], 0
    s_load_dwordx2 s[6:7], s[0:1], 0
    s_load_dwordx2 s[8:9], s[0:1], 96
    s_load_dwordx2 s[10:11], s[0:1], 120
    s_lshr_b32 s12, s2, 7
    s_and_b32 s13, s2, 127
    v_lshrrev_b32 v1, 4, v0
    v_and_b32 v2, 15, v0
    s_lshl_b32 s14, s13, 4
    v_add_u32 v3, s14, v1
    v_mul_u32_u24 v3, 0x480, v3
    v_mul_u32_u24 v4, 72, v2
    v_add_u32 v3, v3, v4
    s_waitcnt lgkmcnt(0)
    s_cmp_eq_u32 s12, 0
    s_cselect_b32 s4, s6, s4
    s_cselect_b32 s5, s7, s5
    s_cselect_b32 s15, 0, 0x240000
    s_cselect_b32 s36, 0, 0
    s_add_u32 s36, s36, 4096
    s_mov_b32 s16, s4
    s_mov_b32 s17, s5
    s_mov_b32 s18, 0x240000
    s_mov_b32 s19, 0x00020000
    s_mov_b32 s20, s8
    s_mov_b32 s21, s9
    s_mov_b32 s22, 0x480
    s_mov_b32 s23, 0x00020000
    s_add_u32 s24, s10, s15
    s_addc_u32 s25, s11, 0
    s_mul_i32 s26, s36, 576
    s_mov_b32 s27, 0x00020000
    s_add_u32 s28, s10, 0xbd0000
    s_addc_u32 s29, s11, 0
    s_mov_b32 s30, 0x2000
    s_mov_b32 s31, 0x00020000
    buffer_load_dwordx2 v[10:11], v3, s[16:19], 0 offen offset:0
    buffer_load_dwordx2 v[12:13], v3, s[16:19], 0 offen offset:8
    buffer_load_dwordx2 v[14:15], v3, s[16:19], 0 offen offset:16
    buffer_load_dwordx2 v[16:17], v3, s[16:19], 0 offen offset:24
    buffer_load_dwordx2 v[18:19], v3, s[16:19], 0 offen offset:32
    buffer_load_dwordx2 v[20:21], v3, s[16:19], 0 offen offset:40
    buffer_load_dwordx2 v[22:23], v3, s[16:19], 0 offen offset:48
    buffer_load_dwordx2 v[24:25], v3, s[16:19], 0 offen offset:56
    buffer_load_dwordx2 v[26:27], v3, s[16:19], 0 offen offset:64
    s_cmp_eq_u32 s12, 0
    s_cbranch_scc0 L_k0_gate
    s_waitcnt vmcnt(0)
    v_lshlrev_b32 v30, 16, v10
    v_and_b32 v31, 0xffff0000, v10
    v_lshlrev_b32 v32, 16, v11
    v_and_b32 v33, 0xffff0000, v11
    v_lshlrev_b32 v34, 16, v12
    v_and_b32 v35, 0xffff0000, v12
    v_lshlrev_b32 v36, 16, v13
    v_and_b32 v37, 0xffff0000, v13
    v_lshlrev_b32 v38, 16, v14
    v_and_b32 v39, 0xffff0000, v14
    v_lshlrev_b32 v40, 16, v15
    v_and_b32 v41, 0xffff0000, v15
    v_lshlrev_b32 v42, 16, v16
    v_and_b32 v43, 0xffff0000, v16
    v_lshlrev_b32 v44, 16, v17
    v_and_b32 v45, 0xffff0000, v17
    v_lshlrev_b32 v46, 16, v18
    v_and_b32 v47, 0xffff0000, v18
    v_lshlrev_b32 v48, 16, v19
    v_and_b32 v49, 0xffff0000, v19
    v_lshlrev_b32 v50, 16, v20
    v_and_b32 v51, 0xffff0000, v20
    v_lshlrev_b32 v52, 16, v21
    v_and_b32 v53, 0xffff0000, v21
    v_lshlrev_b32 v54, 16, v22
    v_and_b32 v55, 0xffff0000, v22
    v_lshlrev_b32 v56, 16, v23
    v_and_b32 v57, 0xffff0000, v23
    v_lshlrev_b32 v58, 16, v24
    v_and_b32 v59, 0xffff0000, v24
    v_lshlrev_b32 v60, 16, v25
    v_and_b32 v61, 0xffff0000, v25
    v_lshlrev_b32 v62, 16, v26
    v_and_b32 v63, 0xffff0000, v26
    v_lshlrev_b32 v64, 16, v27
    v_and_b32 v65, 0xffff0000, v27
    v_add_f32 v5, v30, v31
    v_add_f32 v5, v5, v32
    v_add_f32 v5, v5, v33
    v_add_f32 v5, v5, v34
    v_add_f32 v5, v5, v35
    v_add_f32 v5, v5, v36
    v_add_f32 v5, v5, v37
    v_add_f32 v5, v5, v38
    v_add_f32 v5, v5, v39
    v_add_f32 v5, v5, v40
    v_add_f32 v5, v5, v41
    v_add_f32 v5, v5, v42
    v_add_f32 v5, v5, v43
    v_add_f32 v5, v5, v44
    v_add_f32 v5, v5, v45
    v_add_f32 v5, v5, v46
    v_add_f32 v5, v5, v47
    v_add_f32 v5, v5, v48
    v_add_f32 v5, v5, v49
    v_add_f32 v5, v5, v50
    v_add_f32 v5, v5, v51
    v_add_f32 v5, v5, v52
    v_add_f32 v5, v5, v53
    v_add_f32 v5, v5, v54
    v_add_f32 v5, v5, v55
    v_add_f32 v5, v5, v56
    v_add_f32 v5, v5, v57
    v_add_f32 v5, v5, v58
    v_add_f32 v5, v5, v59
    v_add_f32 v5, v5, v60
    v_add_f32 v5, v5, v61
    v_add_f32 v5, v5, v62
    v_add_f32 v5, v5, v63
    v_add_f32 v5, v5, v64
    v_add_f32 v5, v5, v65
    s_nop 1
    v_add_f32_dpp v5, v5, v5 row_ror:8 row_mask:0xf bank_mask:0xf
    s_nop 1
    v_add_f32_dpp v5, v5, v5 row_ror:4 row_mask:0xf bank_mask:0xf
    s_nop 1
    v_add_f32_dpp v5, v5, v5 row_ror:2 row_mask:0xf bank_mask:0xf
    s_nop 1
    v_add_f32_dpp v5, v5, v5 row_ror:1 row_mask:0xf bank_mask:0xf
    v_mul_f32 v5, 0x3ae38e39, v5
    v_mov_b32 v6, 0
    v_sub_f32 v7, v30, v5
    v_fmac_f32 v6, v7, v7
    v_sub_f32 v7, v31, v5
    v_fmac_f32 v6, v7, v7
    v_sub_f32 v7, v32, v5
    v_fmac_f32 v6, v7, v7
    v_sub_f32 v7, v33, v5
    v_fmac_f32 v6, v7, v7
    v_sub_f32 v7, v34, v5
    v_fmac_f32 v6, v7, v7
    v_sub_f32 v7, v35, v5
    v_fmac_f32 v6, v7, v7
    v_sub_f32 v7, v36, v5
    v_fmac_f32 v6, v7, v7
    v_sub_f32 v7, v37, v5
    v_fmac_f32 v6, v7, v7
    v_sub_f32 v7, v38, v5
    v_fmac_f32 v6, v7, v7
    v_sub_f32 v7, v39, v5
    v_fmac_f32 v6, v7, v7
    v_sub_f32 v7, v40, v5
    v_fmac_f32 v6, v7, v7
    v_sub_f32 v7, v41, v5
    v_fmac_f32 v6, v7, v7
    v_sub_f32 v7, v42, v5
    v_fmac_f32 v6, v7, v7
    v_sub_f32 v7, v43, v5
    v_fmac_f32 v6, v7, v7
    v_sub_f32 v7, v44, v5
    v_fmac_f32 v6, v7, v7
    v_sub_f32 v7, v45, v5
    v_fmac_f32 v6, v7, v7
    v_sub_f32 v7, v46, v5
    v_fmac_f32 v6, v7, v7
    v_sub_f32 v7, v47, v5
    v_fmac_f32 v6, v7, v7
    v_sub_f32 v7, v48, v5
    v_fmac_f32 v6, v7, v7
    v_sub_f32 v7, v49, v5
    v_fmac_f32 v6, v7, v7
    v_sub_f32 v7, v50, v5
    v_fmac_f32 v6, v7, v7
    v_sub_f32 v7, v51, v5
    v_fmac_f32 v6, v7, v7
    v_sub_f32 v7, v52, v5
    v_fmac_f32 v6, v7, v7
    v_sub_f32 v7, v53, v5
    v_fmac_f32 v6, v7, v7
    v_sub_f32 v7, v54, v5
    v_fmac_f32 v6, v7, v7
    v_sub_f32 v7, v55, v5
    v_fmac_f32 v6, v7, v7
    v_sub_f32 v7, v56, v5
    v_fmac_f32 v6, v7, v7
    v_sub_f32 v7, v57, v5
    v_fmac_f32 v6, v7, v7
    v_sub_f32 v7, v58, v5
    v_fmac_f32 v6, v7, v7
    v_sub_f32 v7, v59, v5
    v_fmac_f32 v6, v7, v7
    v_sub_f32 v7, v60, v5
    v_fmac_f32 v6, v7, v7
    v_sub_f32 v7, v61, v5
    v_fmac_f32 v6, v7, v7
    v_sub_f32 v7, v62, v5
    v_fmac_f32 v6, v7, v7
    v_sub_f32 v7, v63, v5
    v_fmac_f32 v6, v7, v7
    v_sub_f32 v7, v64, v5
    v_fmac_f32 v6, v7, v7
    v_sub_f32 v7, v65, v5
    v_fmac_f32 v6, v7, v7
    s_nop 1
    v_add_f32_dpp v6, v6, v6 row_ror:8 row_mask:0xf bank_mask:0xf
    s_nop 1
    v_add_f32_dpp v6, v6, v6 row_ror:4 row_mask:0xf bank_mask:0xf
    s_nop 1
    v_add_f32_dpp v6, v6, v6 row_ror:2 row_mask:0xf bank_mask:0xf
    s_nop 1
    v_add_f32_dpp v6, v6, v6 row_ror:1 row_mask:0xf bank_mask:0xf
    v_mul_f32 v6, 0x3ae38e39, v6
    v_cvt_pk_bf16_f32 v7, v5, v6
    v_lshlrev_b32 v5, 16, v7
    v_and_b32 v6, 0xffff0000, v7
    v_add_f32 v6, 0x3727c5ac, v6
    v_mov_b32 v8, v6
    v_cvt_pk_bf16_f32 v7, v6, v8
    v_lshlrev_b32 v6, 16, v7
    v_and_b32 v8, 0xffff0000, v7
    v_sqrt_f32 v6, v6
    s_nop 0
    v_mov_b32 v8, v6
    v_cvt_pk_bf16_f32 v7, v6, v8
    v_lshlrev_b32 v6, 16, v7
    v_and_b32 v8, 0xffff0000, v7
    v_rcp_f32 v8, v6
    s_nop 0
    v_fma_f32 v9, -v6, v8, 2.0
    v_mul_f32 v8, v8, v9
    v_sub_f32 v30, v30, v5
    v_sub_f32 v31, v31, v5
    v_cvt_pk_bf16_f32 v7, v30, v31
    v_lshlrev_b32 v30, 16, v7
    v_and_b32 v31, 0xffff0000, v7
    v_mul_f32 v30, v30, v8
    v_mul_f32 v31, v31, v8
    v_cvt_pk_bf16_f32 v10, v30, v31
    v_sub_f32 v32, v32, v5
    v_sub_f32 v33, v33, v5
    v_cvt_pk_bf16_f32 v7, v32, v33
    v_lshlrev_b32 v32, 16, v7
    v_and_b32 v33, 0xffff0000, v7
    v_mul_f32 v32, v32, v8
    v_mul_f32 v33, v33, v8
    v_cvt_pk_bf16_f32 v11, v32, v33
    v_sub_f32 v34, v34, v5
    v_sub_f32 v35, v35, v5
    v_cvt_pk_bf16_f32 v7, v34, v35
    v_lshlrev_b32 v34, 16, v7
    v_and_b32 v35, 0xffff0000, v7
    v_mul_f32 v34, v34, v8
    v_mul_f32 v35, v35, v8
    v_cvt_pk_bf16_f32 v12, v34, v35
    v_sub_f32 v36, v36, v5
    v_sub_f32 v37, v37, v5
    v_cvt_pk_bf16_f32 v7, v36, v37
    v_lshlrev_b32 v36, 16, v7
    v_and_b32 v37, 0xffff0000, v7
    v_mul_f32 v36, v36, v8
    v_mul_f32 v37, v37, v8
    v_cvt_pk_bf16_f32 v13, v36, v37
    v_sub_f32 v38, v38, v5
    v_sub_f32 v39, v39, v5
    v_cvt_pk_bf16_f32 v7, v38, v39
    v_lshlrev_b32 v38, 16, v7
    v_and_b32 v39, 0xffff0000, v7
    v_mul_f32 v38, v38, v8
    v_mul_f32 v39, v39, v8
    v_cvt_pk_bf16_f32 v14, v38, v39
    v_sub_f32 v40, v40, v5
    v_sub_f32 v41, v41, v5
    v_cvt_pk_bf16_f32 v7, v40, v41
    v_lshlrev_b32 v40, 16, v7
    v_and_b32 v41, 0xffff0000, v7
    v_mul_f32 v40, v40, v8
    v_mul_f32 v41, v41, v8
    v_cvt_pk_bf16_f32 v15, v40, v41
    v_sub_f32 v42, v42, v5
    v_sub_f32 v43, v43, v5
    v_cvt_pk_bf16_f32 v7, v42, v43
    v_lshlrev_b32 v42, 16, v7
    v_and_b32 v43, 0xffff0000, v7
    v_mul_f32 v42, v42, v8
    v_mul_f32 v43, v43, v8
    v_cvt_pk_bf16_f32 v16, v42, v43
    v_sub_f32 v44, v44, v5
    v_sub_f32 v45, v45, v5
    v_cvt_pk_bf16_f32 v7, v44, v45
    v_lshlrev_b32 v44, 16, v7
    v_and_b32 v45, 0xffff0000, v7
    v_mul_f32 v44, v44, v8
    v_mul_f32 v45, v45, v8
    v_cvt_pk_bf16_f32 v17, v44, v45
    v_sub_f32 v46, v46, v5
    v_sub_f32 v47, v47, v5
    v_cvt_pk_bf16_f32 v7, v46, v47
    v_lshlrev_b32 v46, 16, v7
    v_and_b32 v47, 0xffff0000, v7
    v_mul_f32 v46, v46, v8
    v_mul_f32 v47, v47, v8
    v_cvt_pk_bf16_f32 v18, v46, v47
    v_sub_f32 v48, v48, v5
    v_sub_f32 v49, v49, v5
    v_cvt_pk_bf16_f32 v7, v48, v49
    v_lshlrev_b32 v48, 16, v7
    v_and_b32 v49, 0xffff0000, v7
    v_mul_f32 v48, v48, v8
    v_mul_f32 v49, v49, v8
    v_cvt_pk_bf16_f32 v19, v48, v49
    v_sub_f32 v50, v50, v5
    v_sub_f32 v51, v51, v5
    v_cvt_pk_bf16_f32 v7, v50, v51
    v_lshlrev_b32 v50, 16, v7
    v_and_b32 v51, 0xffff0000, v7
    v_mul_f32 v50, v50, v8
    v_mul_f32 v51, v51, v8
    v_cvt_pk_bf16_f32 v20, v50, v51
    v_sub_f32 v52, v52, v5
    v_sub_f32 v53, v53, v5
    v_cvt_pk_bf16_f32 v7, v52, v53
    v_lshlrev_b32 v52, 16, v7
    v_and_b32 v53, 0xffff0000, v7
    v_mul_f32 v52, v52, v8
    v_mul_f32 v53, v53, v8
    v_cvt_pk_bf16_f32 v21, v52, v53
    v_sub_f32 v54, v54, v5
    v_sub_f32 v55, v55, v5
    v_cvt_pk_bf16_f32 v7, v54, v55
    v_lshlrev_b32 v54, 16, v7
    v_and_b32 v55, 0xffff0000, v7
    v_mul_f32 v54, v54, v8
    v_mul_f32 v55, v55, v8
    v_cvt_pk_bf16_f32 v22, v54, v55
    v_sub_f32 v56, v56, v5
    v_sub_f32 v57, v57, v5
    v_cvt_pk_bf16_f32 v7, v56, v57
    v_lshlrev_b32 v56, 16, v7
    v_and_b32 v57, 0xffff0000, v7
    v_mul_f32 v56, v56, v8
    v_mul_f32 v57, v57, v8
    v_cvt_pk_bf16_f32 v23, v56, v57
    v_sub_f32 v58, v58, v5
    v_sub_f32 v59, v59, v5
    v_cvt_pk_bf16_f32 v7, v58, v59
    v_lshlrev_b32 v58, 16, v7
    v_and_b32 v59, 0xffff0000, v7
    v_mul_f32 v58, v58, v8
    v_mul_f32 v59, v59, v8
    v_cvt_pk_bf16_f32 v24, v58, v59
    v_sub_f32 v60, v60, v5
    v_sub_f32 v61, v61, v5
    v_cvt_pk_bf16_f32 v7, v60, v61
    v_lshlrev_b32 v60, 16, v7
    v_and_b32 v61, 0xffff0000, v7
    v_mul_f32 v60, v60, v8
    v_mul_f32 v61, v61, v8
    v_cvt_pk_bf16_f32 v25, v60, v61
    v_sub_f32 v62, v62, v5
    v_sub_f32 v63, v63, v5
    v_cvt_pk_bf16_f32 v7, v62, v63
    v_lshlrev_b32 v62, 16, v7
    v_and_b32 v63, 0xffff0000, v7
    v_mul_f32 v62, v62, v8
    v_mul_f32 v63, v63, v8
    v_cvt_pk_bf16_f32 v26, v62, v63
    v_sub_f32 v64, v64, v5
    v_sub_f32 v65, v65, v5
    v_cvt_pk_bf16_f32 v7, v64, v65
    v_lshlrev_b32 v64, 16, v7
    v_and_b32 v65, 0xffff0000, v7
    v_mul_f32 v64, v64, v8
    v_mul_f32 v65, v65, v8
    v_cvt_pk_bf16_f32 v27, v64, v65
    s_branch L_k0_store
L_k0_gate:
    buffer_load_dwordx2 v[70:71], v4, s[20:23], 0 offen offset:0
    buffer_load_dwordx2 v[72:73], v4, s[20:23], 0 offen offset:8
    buffer_load_dwordx2 v[74:75], v4, s[20:23], 0 offen offset:16
    buffer_load_dwordx2 v[76:77], v4, s[20:23], 0 offen offset:24
    buffer_load_dwordx2 v[78:79], v4, s[20:23], 0 offen offset:32
    buffer_load_dwordx2 v[80:81], v4, s[20:23], 0 offen offset:40
    buffer_load_dwordx2 v[82:83], v4, s[20:23], 0 offen offset:48
    buffer_load_dwordx2 v[84:85], v4, s[20:23], 0 offen offset:56
    buffer_load_dwordx2 v[86:87], v4, s[20:23], 0 offen offset:64
    s_waitcnt vmcnt(0)
    v_mov_b32 v5, 0
    v_lshlrev_b32 v30, 16, v10
    v_and_b32 v31, 0xffff0000, v10
    v_lshlrev_b32 v32, 16, v70
    v_and_b32 v33, 0xffff0000, v70
    v_mul_f32 v30, v30, v32
    v_mul_f32 v31, v31, v33
    v_cvt_pk_bf16_f32 v7, v30, v31
    v_lshlrev_b32 v30, 16, v7
    v_and_b32 v31, 0xffff0000, v7
    v_add_f32 v5, v5, v30
    v_add_f32 v5, v5, v31
    v_lshlrev_b32 v30, 16, v11
    v_and_b32 v31, 0xffff0000, v11
    v_lshlrev_b32 v32, 16, v71
    v_and_b32 v33, 0xffff0000, v71
    v_mul_f32 v30, v30, v32
    v_mul_f32 v31, v31, v33
    v_cvt_pk_bf16_f32 v7, v30, v31
    v_lshlrev_b32 v30, 16, v7
    v_and_b32 v31, 0xffff0000, v7
    v_add_f32 v5, v5, v30
    v_add_f32 v5, v5, v31
    v_lshlrev_b32 v30, 16, v12
    v_and_b32 v31, 0xffff0000, v12
    v_lshlrev_b32 v32, 16, v72
    v_and_b32 v33, 0xffff0000, v72
    v_mul_f32 v30, v30, v32
    v_mul_f32 v31, v31, v33
    v_cvt_pk_bf16_f32 v7, v30, v31
    v_lshlrev_b32 v30, 16, v7
    v_and_b32 v31, 0xffff0000, v7
    v_add_f32 v5, v5, v30
    v_add_f32 v5, v5, v31
    v_lshlrev_b32 v30, 16, v13
    v_and_b32 v31, 0xffff0000, v13
    v_lshlrev_b32 v32, 16, v73
    v_and_b32 v33, 0xffff0000, v73
    v_mul_f32 v30, v30, v32
    v_mul_f32 v31, v31, v33
    v_cvt_pk_bf16_f32 v7, v30, v31
    v_lshlrev_b32 v30, 16, v7
    v_and_b32 v31, 0xffff0000, v7
    v_add_f32 v5, v5, v30
    v_add_f32 v5, v5, v31
    v_lshlrev_b32 v30, 16, v14
    v_and_b32 v31, 0xffff0000, v14
    v_lshlrev_b32 v32, 16, v74
    v_and_b32 v33, 0xffff0000, v74
    v_mul_f32 v30, v30, v32
    v_mul_f32 v31, v31, v33
    v_cvt_pk_bf16_f32 v7, v30, v31
    v_lshlrev_b32 v30, 16, v7
    v_and_b32 v31, 0xffff0000, v7
    v_add_f32 v5, v5, v30
    v_add_f32 v5, v5, v31
    v_lshlrev_b32 v30, 16, v15
    v_and_b32 v31, 0xffff0000, v15
    v_lshlrev_b32 v32, 16, v75
    v_and_b32 v33, 0xffff0000, v75
    v_mul_f32 v30, v30, v32
    v_mul_f32 v31, v31, v33
    v_cvt_pk_bf16_f32 v7, v30, v31
    v_lshlrev_b32 v30, 16, v7
    v_and_b32 v31, 0xffff0000, v7
    v_add_f32 v5, v5, v30
    v_add_f32 v5, v5, v31
    v_lshlrev_b32 v30, 16, v16
    v_and_b32 v31, 0xffff0000, v16
    v_lshlrev_b32 v32, 16, v76
    v_and_b32 v33, 0xffff0000, v76
    v_mul_f32 v30, v30, v32
    v_mul_f32 v31, v31, v33
    v_cvt_pk_bf16_f32 v7, v30, v31
    v_lshlrev_b32 v30, 16, v7
    v_and_b32 v31, 0xffff0000, v7
    v_add_f32 v5, v5, v30
    v_add_f32 v5, v5, v31
    v_lshlrev_b32 v30, 16, v17
    v_and_b32 v31, 0xffff0000, v17
    v_lshlrev_b32 v32, 16, v77
    v_and_b32 v33, 0xffff0000, v77
    v_mul_f32 v30, v30, v32
    v_mul_f32 v31, v31, v33
    v_cvt_pk_bf16_f32 v7, v30, v31
    v_lshlrev_b32 v30, 16, v7
    v_and_b32 v31, 0xffff0000, v7
    v_add_f32 v5, v5, v30
    v_add_f32 v5, v5, v31
    v_lshlrev_b32 v30, 16, v18
    v_and_b32 v31, 0xffff0000, v18
    v_lshlrev_b32 v32, 16, v78
    v_and_b32 v33, 0xffff0000, v78
    v_mul_f32 v30, v30, v32
    v_mul_f32 v31, v31, v33
    v_cvt_pk_bf16_f32 v7, v30, v31
    v_lshlrev_b32 v30, 16, v7
    v_and_b32 v31, 0xffff0000, v7
    v_add_f32 v5, v5, v30
    v_add_f32 v5, v5, v31
    v_lshlrev_b32 v30, 16, v19
    v_and_b32 v31, 0xffff0000, v19
    v_lshlrev_b32 v32, 16, v79
    v_and_b32 v33, 0xffff0000, v79
    v_mul_f32 v30, v30, v32
    v_mul_f32 v31, v31, v33
    v_cvt_pk_bf16_f32 v7, v30, v31
    v_lshlrev_b32 v30, 16, v7
    v_and_b32 v31, 0xffff0000, v7
    v_add_f32 v5, v5, v30
    v_add_f32 v5, v5, v31
    v_lshlrev_b32 v30, 16, v20
    v_and_b32 v31, 0xffff0000, v20
    v_lshlrev_b32 v32, 16, v80
    v_and_b32 v33, 0xffff0000, v80
    v_mul_f32 v30, v30, v32
    v_mul_f32 v31, v31, v33
    v_cvt_pk_bf16_f32 v7, v30, v31
    v_lshlrev_b32 v30, 16, v7
    v_and_b32 v31, 0xffff0000, v7
    v_add_f32 v5, v5, v30
    v_add_f32 v5, v5, v31
    v_lshlrev_b32 v30, 16, v21
    v_and_b32 v31, 0xffff0000, v21
    v_lshlrev_b32 v32, 16, v81
    v_and_b32 v33, 0xffff0000, v81
    v_mul_f32 v30, v30, v32
    v_mul_f32 v31, v31, v33
    v_cvt_pk_bf16_f32 v7, v30, v31
    v_lshlrev_b32 v30, 16, v7
    v_and_b32 v31, 0xffff0000, v7
    v_add_f32 v5, v5, v30
    v_add_f32 v5, v5, v31
    v_lshlrev_b32 v30, 16, v22
    v_and_b32 v31, 0xffff0000, v22
    v_lshlrev_b32 v32, 16, v82
    v_and_b32 v33, 0xffff0000, v82
    v_mul_f32 v30, v30, v32
    v_mul_f32 v31, v31, v33
    v_cvt_pk_bf16_f32 v7, v30, v31
    v_lshlrev_b32 v30, 16, v7
    v_and_b32 v31, 0xffff0000, v7
    v_add_f32 v5, v5, v30
    v_add_f32 v5, v5, v31
    v_lshlrev_b32 v30, 16, v23
    v_and_b32 v31, 0xffff0000, v23
    v_lshlrev_b32 v32, 16, v83
    v_and_b32 v33, 0xffff0000, v83
    v_mul_f32 v30, v30, v32
    v_mul_f32 v31, v31, v33
    v_cvt_pk_bf16_f32 v7, v30, v31
    v_lshlrev_b32 v30, 16, v7
    v_and_b32 v31, 0xffff0000, v7
    v_add_f32 v5, v5, v30
    v_add_f32 v5, v5, v31
    v_lshlrev_b32 v30, 16, v24
    v_and_b32 v31, 0xffff0000, v24
    v_lshlrev_b32 v32, 16, v84
    v_and_b32 v33, 0xffff0000, v84
    v_mul_f32 v30, v30, v32
    v_mul_f32 v31, v31, v33
    v_cvt_pk_bf16_f32 v7, v30, v31
    v_lshlrev_b32 v30, 16, v7
    v_and_b32 v31, 0xffff0000, v7
    v_add_f32 v5, v5, v30
    v_add_f32 v5, v5, v31
    v_lshlrev_b32 v30, 16, v25
    v_and_b32 v31, 0xffff0000, v25
    v_lshlrev_b32 v32, 16, v85
    v_and_b32 v33, 0xffff0000, v85
    v_mul_f32 v30, v30, v32
    v_mul_f32 v31, v31, v33
    v_cvt_pk_bf16_f32 v7, v30, v31
    v_lshlrev_b32 v30, 16, v7
    v_and_b32 v31, 0xffff0000, v7
    v_add_f32 v5, v5, v30
    v_add_f32 v5, v5, v31
    v_lshlrev_b32 v30, 16, v26
    v_and_b32 v31, 0xffff0000, v26
    v_lshlrev_b32 v32, 16, v86
    v_and_b32 v33, 0xffff0000, v86
    v_mul_f32 v30, v30, v32
    v_mul_f32 v31, v31, v33
    v_cvt_pk_bf16_f32 v7, v30, v31
    v_lshlrev_b32 v30, 16, v7
    v_and_b32 v31, 0xffff0000, v7
    v_add_f32 v5, v5, v30
    v_add_f32 v5, v5, v31
    v_lshlrev_b32 v30, 16, v27
    v_and_b32 v31, 0xffff0000, v27
    v_lshlrev_b32 v32, 16, v87
    v_and_b32 v33, 0xffff0000, v87
    v_mul_f32 v30, v30, v32
    v_mul_f32 v31, v31, v33
    v_cvt_pk_bf16_f32 v7, v30, v31
    v_lshlrev_b32 v30, 16, v7
    v_and_b32 v31, 0xffff0000, v7
    v_add_f32 v5, v5, v30
    v_add_f32 v5, v5, v31
    s_nop 1
    v_add_f32_dpp v5, v5, v5 row_ror:8 row_mask:0xf bank_mask:0xf
    s_nop 1
    v_add_f32_dpp v5, v5, v5 row_ror:4 row_mask:0xf bank_mask:0xf
    s_nop 1
    v_add_f32_dpp v5, v5, v5 row_ror:2 row_mask:0xf bank_mask:0xf
    s_nop 1
    v_add_f32_dpp v5, v5, v5 row_ror:1 row_mask:0xf bank_mask:0xf
    v_mov_b32 v6, v5
    v_cvt_pk_bf16_f32 v7, v5, v6
    v_lshlrev_b32 v5, 16, v7
    v_and_b32 v6, 0xffff0000, v7
    v_mul_f32 v5, 0xbfb8aa3b, v5
    v_exp_f32 v5, v5
    s_nop 0
    v_add_f32 v5, 1.0, v5
    v_rcp_f32 v6, v5
    s_nop 0
    v_fma_f32 v9, -v5, v6, 2.0
    v_mul_f32 v5, v6, v9
    v_mov_b32 v6, v5
    v_cvt_pk_bf16_f32 v7, v5, v6
    v_lshlrev_b32 v5, 16, v7
    v_and_b32 v6, 0xffff0000, v7
    v_add_u32 v6, s14, v1
    v_lshlrev_b32 v6, 2, v6
    v_cmp_eq_u32 vcc, 0, v2
    s_and_saveexec_b64 s[32:33], vcc
    buffer_store_dword v5, v6, s[28:31], 0 offen
    s_mov_b64 exec, s[32:33]
L_k0_store:
    v_mul_u32_u24 v4, 0x490, v2
    v_lshl_add_u32 v4, v1, 1, v4
    ds_write_b16 v4, v10 offset:0
    ds_write_b16_d16_hi v4, v10 offset:32
    ds_write_b16 v4, v11 offset:64
    ds_write_b16_d16_hi v4, v11 offset:96
    ds_write_b16 v4, v12 offset:128
    ds_write_b16_d16_hi v4, v12 offset:160
    ds_write_b16 v4, v13 offset:192
    ds_write_b16_d16_hi v4, v13 offset:224
    ds_write_b16 v4, v14 offset:256
    ds_write_b16_d16_hi v4, v14 offset:288
    ds_write_b16 v4, v15 offset:320
    ds_write_b16_d16_hi v4, v15 offset:352
    ds_write_b16 v4, v16 offset:384
    ds_write_b16_d16_hi v4, v16 offset:416
    ds_write_b16 v4, v17 offset:448
    ds_write_b16_d16_hi v4, v17 offset:480
    ds_write_b16 v4, v18 offset:512
    ds_write_b16_d16_hi v4, v18 offset:544
    ds_write_b16 v4, v19 offset:576
    ds_write_b16_d16_hi v4, v19 offset:608
    ds_write_b16 v4, v20 offset:640
    ds_write_b16_d16_hi v4, v20 offset:672
    ds_write_b16 v4, v21 offset:704
    ds_write_b16_d16_hi v4, v21 offset:736
    ds_write_b16 v4, v22 offset:768
    ds_write_b16_d16_hi v4, v22 offset:800
    ds_write_b16 v4, v23 offset:832
    ds_write_b16_d16_hi v4, v23 offset:864
    ds_write_b16 v4, v24 offset:896
    ds_write_b16_d16_hi v4, v24 offset:928
    ds_write_b16 v4, v25 offset:960
    ds_write_b16_d16_hi v4, v25 offset:992
    ds_write_b16 v4, v26 offset:1024
    ds_write_b16_d16_hi v4, v26 offset:1056
    ds_write_b16 v4, v27 offset:1088
    ds_write_b16_d16_hi v4, v27 offset:1120
    s_waitcnt lgkmcnt(0)
    s_barrier
    v_lshlrev_b32 v4, 5, v0
    v_mov_b32 v6, 1821
    v_add_u32 v7, 0, v0
    v_mul_u32_u24 v7, v7, v6
    v_lshrrev_b32 v7, 16, v7
    v_lshl_add_u32 v20, v7, 4, v4
    v_add_u32 v7, 256, v0
    v_mul_u32_u24 v7, v7, v6
    v_lshrrev_b32 v7, 16, v7
    v_lshl_add_u32 v21, v7, 4, v4
    v_add_u32 v7, 512, v0
    v_mul_u32_u24 v7, v7, v6
    v_lshrrev_b32 v7, 16, v7
    v_lshl_add_u32 v22, v7, 4, v4
    v_mul_lo_u32 v5, v0, s36
    s_lshl_b32 s14, s13, 5
    v_add_u32 v5, s14, v5
    v_readfirstlane_b32 s34, v0
    ds_read_b128 v[10:13], v20 offset:0
    ds_read_b128 v[14:17], v20 offset:16
    s_waitcnt lgkmcnt(0)
    s_mul_i32 s35, s36, 0
    buffer_store_dwordx4 v[10:13], v5, s[24:27], s35 offen
    buffer_store_dwordx4 v[14:17], v5, s[24:27], s35 offen offset:16
    s_nop 1
    ds_read_b128 v[10:13], v21 offset:8192
    ds_read_b128 v[14:17], v21 offset:8208
    s_waitcnt lgkmcnt(0)
    s_mul_i32 s35, s36, 256
    buffer_store_dwordx4 v[10:13], v5, s[24:27], s35 offen
    buffer_store_dwordx4 v[14:17], v5, s[24:27], s35 offen offset:16
    s_nop 1
    s_cmp_ge_u32 s34, 64
    s_cbranch_scc1 L_k0_done
    ds_read_b128 v[10:13], v22 offset:16384
    ds_read_b128 v[14:17], v22 offset:16400
    s_waitcnt lgkmcnt(0)
    s_mul_i32 s35, s36, 512
    buffer_store_dwordx4 v[10:13], v5, s[24:27], s35 offen
    buffer_store_dwordx4 v[14:17], v5, s[24:27], s35 offen offset:16
    s_nop 1
L_k0_done:
    s_endpgm
.section .rodata,"a"
.p2align 6
.amdhsa_kernel prep_kernel
  .amdhsa_next_free_vgpr 96
  .amdhsa_next_free_sgpr 102
  .amdhsa_accum_offset 96
  .amdhsa_group_segment_fixed_size 0
  .amdhsa_kernarg_size 128
  .amdhsa_user_sgpr_count 2
  .amdhsa_user_sgpr_kernarg_segment_ptr 1
  .amdhsa_system_sgpr_workgroup_id_x 1
.end_amdhsa_kernel
.text
.globl mix_kernel
.p2align 8
.type mix_kernel,@function
mix_kernel:
    s_cmp_ge_u32 s2, 216
    s_cbranch_scc1 L_mix_ssm
    s_setprio 0
    s_load_dwordx2 s[4:5], s[0:1], 64
    s_load_dwordx2 s[6:7], s[0:1], 72
    s_load_dwordx2 s[10:11], s[0:1], 120
    s_and_b32 s12, s2, 7
    s_lshr_b32 s13, s2, 3
    s_mul_i32 s12, s12, 27
    s_add_u32 s12, s12, s13
    s_mul_hi_u32 s13, s12, 0x2aaaaaab
    s_mul_i32 s14, s13, 6
    s_sub_u32 s14, s12, s14
    v_lshrrev_b32 v1, 6, v0
    v_and_b32 v2, 63, v0
    s_nop 0
    v_readfirstlane_b32 s15, v1
    s_waitcnt lgkmcnt(0)
    s_mov_b32 s16, s4
    s_mov_b32 s17, s5
    s_mov_b32 s18, 0x1200000
    s_mov_b32 s19, 0x00020000
    s_mov_b32 s20, s10
    s_mov_b32 s21, s11
    s_mov_b32 s22, 0x240000
    s_mov_b32 s23, 0x00020000
    s_mov_b32 s24, s6
    s_mov_b32 s25, s7
    s_mov_b32 s26, 0x2400
    s_mov_b32 s27, 0x00020000
    s_add_u32 s28, s10, 0x480000
    s_addc_u32 s29, s11, 0
    s_mov_b32 s30, 0x510000
    s_mov_b32 s31, 0x00020000
    v_lshrrev_b32 v3, 4, v2
    v_and_b32 v4, 15, v2
    v_lshrrev_b32 v5, 2, v4
    v_xor_b32 v5, v5, v3
    v_lshlrev_b32 v5, 6, v5
    v_and_b32 v6, 3, v2
    v_lshl_add_u32 v5, v6, 4, v5
    v_mul_u32_u24 v6, 0x2400, v3
    v_add_u32 v200, v5, v6
    v_lshrrev_b32 v5, 3, v2
    v_and_b32 v6, 7, v2
    v_xor_b32 v7, v6, v3
    v_lshlrev_b32 v7, 4, v7
    v_mul_u32_u24 v5, 4096, v5
    v_add_u32 v201, v5, v7
    v_xor_b32 v202, 64, v201
    s_lshl_b32 s34, s13, 8
    s_mul_i32 s35, s15, 147456
    s_add_u32 s34, s34, s35
    s_mul_i32 s35, s14, 96
    s_mul_i32 s36, s15, 24
    s_add_u32 s35, s35, s36
    s_mul_i32 s35, s35, 4096
    s_lshl_b32 s36, s15, 12
    s_mul_i32 s37, s15, 3072
    s_add_u32 s37, s37, 49152
    s_lshr_b32 s38, s15, 1
    s_and_b32 s39, s15, 1
    v_lshrrev_b32 v5, 5, v2
    v_lshrrev_b32 v6, 2, v4
    v_lshl_add_u32 v7, v5, 3, v6
    v_lshlrev_b32 v7, 8, v7
    v_bfe_u32 v8, v2, 4, 1
    v_lshlrev_b32 v8, 5, v8
    v_and_b32 v9, 3, v2
    v_lshl_add_u32 v8, v9, 3, v8
    v_add_u32 v7, v7, v8
    s_lshl_b32 s41, s39, 13
    v_add_u32 v7, s41, v7
    s_lshl_b32 s41, s38, 1
    v_xor_b32 v8, s41, v6
    v_lshl_add_u32 v204, v8, 6, v7
    s_add_u32 s41, s41, 1
    v_xor_b32 v8, s41, v6
    v_lshl_add_u32 v205, v8, 6, v7
    v_and_b32 v8, 31, v2
    v_bfe_u32 v9, v8, 1, 3
    s_lshl_b32 s41, s39, 2
    v_add_u32 v10, s41, v5
    v_xor_b32 v11, v10, v9
    v_lshlrev_b32 v11, 4, v11
    v_lshl_add_u32 v206, v8, 7, v11
    v_add_u32 v10, 2, v10
    v_xor_b32 v11, v10, v9
    v_lshlrev_b32 v11, 4, v11
    v_lshl_add_u32 v207, v8, 7, v11
    v_add_u32 v206, 49152, v206
    v_add_u32 v207, 49152, v207
    s_lshl_b32 s41, s13, 8
    s_lshl_b32 s42, s15, 6
    s_add_u32 s41, s41, s42
    v_lshlrev_b32 v12, 3, v5
    v_add_u32 v12, s41, v12
    v_mov_b32 v222, v12
    buffer_load_dwordx2 v[212:213], v12, s[24:27], 0 offen offset:0
    buffer_load_dwordx2 v[214:215], v12, s[24:27], 0 offen offset:16
    buffer_load_dwordx2 v[216:217], v12, s[24:27], 0 offen offset:32
    buffer_load_dwordx2 v[218:219], v12, s[24:27], 0 offen offset:48
    v_mov_b32 v220, v201
    v_mov_b32 v221, v202
    s_and_b32 s41, s15, 1
    s_cmp_eq_u32 s41, 0
    s_cbranch_scc1 L_g1_par
    v_mov_b32 v220, v202
    v_mov_b32 v221, v201
L_g1_par:
    s_mov_b32 s68, s14
    s_mov_b32 s69, 0
    s_mov_b32 s70, 0
    s_mov_b32 s71, s14
    s_mov_b32 s72, 0
    s_mov_b32 s73, 0
    s_mov_b32 s74, s34
    s_mov_b32 s75, s35
    s_mul_i32 s76, s14, 589824
    s_add_u32 s34, s34, s76
    s_lshl_b32 s76, s14, 7
    s_add_u32 s35, s35, s76
    s_add_u32 m0, s36, 0
    s_add_u32 s42, s34, 0
    buffer_load_dwordx4 v200, s[16:19], s42 offen lds
    s_add_u32 m0, s36, 1024
    s_add_u32 s42, s34, 36864
    buffer_load_dwordx4 v200, s[16:19], s42 offen lds
    s_add_u32 m0, s36, 2048
    s_add_u32 s42, s34, 73728
    buffer_load_dwordx4 v200, s[16:19], s42 offen lds
    s_add_u32 m0, s36, 3072
    s_add_u32 s42, s34, 110592
    buffer_load_dwordx4 v200, s[16:19], s42 offen lds
    s_add_u32 s68, s68, 1
    s_cmp_eq_u32 s68, 8
    s_cselect_b32 s68, 0, s68
    s_add_u32 s69, s69, 1
    s_cmp_eq_u32 s69, 8
    s_cselect_b32 s69, 0, s69
    s_cselect_b32 s76, 8, 0
    s_add_u32 s70, s70, s76
    s_add_u32 s76, s70, s68
    s_mul_i32 s76, s76, 589824
    s_add_u32 s34, s74, s76
    s_add_u32 m0, s37, 0
    s_add_u32 s42, s35, 0
    buffer_load_dwordx4 v220, s[20:23], s42 offen lds
    s_add_u32 m0, s37, 1024
    s_add_u32 s42, s35, 32768
    buffer_load_dwordx4 v221, s[20:23], s42 offen lds
    s_add_u32 m0, s37, 2048
    s_add_u32 s42, s35, 65536
    buffer_load_dwordx4 v220, s[20:23], s42 offen lds
    s_add_u32 s71, s71, 1
    s_cmp_eq_u32 s71, 8
    s_cselect_b32 s71, 0, s71
    s_add_u32 s72, s72, 1
    s_cmp_eq_u32 s72, 8
    s_cselect_b32 s72, 0, s72
    s_cselect_b32 s76, 8, 0
    s_add_u32 s73, s73, s76
    s_add_u32 s76, s73, s71
    s_mul_i32 s76, s76, 128
    s_add_u32 s35, s75, s76
    s_add_u32 m0, s36, 16384
    s_add_u32 s42, s34, 0
    buffer_load_dwordx4 v200, s[16:19], s42 offen lds
    s_add_u32 m0, s36, 17408
    s_add_u32 s42, s34, 36864
    buffer_load_dwordx4 v200, s[16:19], s42 offen lds
    s_add_u32 m0, s36, 18432
    s_add_u32 s42, s34, 73728
    buffer_load_dwordx4 v200, s[16:19], s42 offen lds
    s_add_u32 m0, s36, 19456
    s_add_u32 s42, s34, 110592
    buffer_load_dwordx4 v200, s[16:19], s42 offen lds
    s_add_u32 s68, s68, 1
    s_cmp_eq_u32 s68, 8
    s_cselect_b32 s68, 0, s68
    s_add_u32 s69, s69, 1
    s_cmp_eq_u32 s69, 8
    s_cselect_b32 s69, 0, s69
    s_cselect_b32 s76, 8, 0
    s_add_u32 s70, s70, s76
    s_add_u32 s76, s70, s68
    s_mul_i32 s76, s76, 589824
    s_add_u32 s34, s74, s76
    v_mov_b32 v100, 0
    v_mov_b32 v101, 0
    v_mov_b32 v102, 0
    v_mov_b32 v103, 0
    v_mov_b32 v104, 0
    v_mov_b32 v105, 0
    v_mov_b32 v106, 0
    v_mov_b32 v107, 0
    v_mov_b32 v108, 0
    v_mov_b32 v109, 0
    v_mov_b32 v110, 0
    v_mov_b32 v111, 0
    v_mov_b32 v112, 0
    v_mov_b32 v113, 0
    v_mov_b32 v114, 0
    v_mov_b32 v115, 0
    v_mov_b32 v116, 0
    v_mov_b32 v117, 0
    v_mov_b32 v118, 0
    v_mov_b32 v119, 0
    v_mov_b32 v120, 0
    v_mov_b32 v121, 0
    v_mov_b32 v122, 0
    v_mov_b32 v123, 0
    v_mov_b32 v124, 0
    v_mov_b32 v125, 0
    v_mov_b32 v126, 0
    v_mov_b32 v127, 0
    v_mov_b32 v128, 0
    v_mov_b32 v129, 0
    v_mov_b32 v130, 0
    v_mov_b32 v131, 0
    v_mov_b32 v132, 0
    v_mov_b32 v133, 0
    v_mov_b32 v134, 0
    v_mov_b32 v135, 0
    v_mov_b32 v136, 0
    v_mov_b32 v137, 0
    v_mov_b32 v138, 0
    v_mov_b32 v139, 0
    v_mov_b32 v140, 0
    v_mov_b32 v141, 0
    v_mov_b32 v142, 0
    v_mov_b32 v143, 0
    v_mov_b32 v144, 0
    v_mov_b32 v145, 0
    v_mov_b32 v146, 0
    v_mov_b32 v147, 0
    v_mov_b32 v148, 0
    v_mov_b32 v149, 0
    v_mov_b32 v150, 0
    v_mov_b32 v151, 0
    v_mov_b32 v152, 0
    v_mov_b32 v153, 0
    v_mov_b32 v154, 0
    v_mov_b32 v155, 0
    v_mov_b32 v156, 0
    v_mov_b32 v157, 0
    v_mov_b32 v158, 0
    v_mov_b32 v159, 0
    v_mov_b32 v160, 0
    v_mov_b32 v161, 0
    v_mov_b32 v162, 0
    v_mov_b32 v163, 0
    v_mov_b32 v164, 0
    v_mov_b32 v165, 0
    v_mov_b32 v166, 0
    v_mov_b32 v167, 0
    v_mov_b32 v168, 0
    v_mov_b32 v169, 0
    v_mov_b32 v170, 0
    v_mov_b32 v171, 0
    v_mov_b32 v172, 0
    v_mov_b32 v173, 0
    v_mov_b32 v174, 0
    v_mov_b32 v175, 0
    v_mov_b32 v176, 0
    v_mov_b32 v177, 0
    v_mov_b32 v178, 0
    v_mov_b32 v179, 0
    v_mov_b32 v180, 0
    v_mov_b32 v181, 0
    v_mov_b32 v182, 0
    v_mov_b32 v183, 0
    v_mov_b32 v184, 0
    v_mov_b32 v185, 0
    v_mov_b32 v186, 0
    v_mov_b32 v187, 0
    v_mov_b32 v188, 0
    v_mov_b32 v189, 0
    v_mov_b32 v190, 0
    v_mov_b32 v191, 0
    v_mov_b32 v192, 0
    v_mov_b32 v193, 0
    v_mov_b32 v194, 0
    v_mov_b32 v195, 0
    s_waitcnt vmcnt(4)
    s_barrier
    ds_read_b64_tr_b16 v[10:11], v204 offset:0
    ds_read_b64_tr_b16 v[12:13], v204 offset:1024
    ds_read_b64_tr_b16 v[14:15], v205 offset:0
    ds_read_b64_tr_b16 v[16:17], v205 offset:1024
    ds_read_b128 v[18:21], v206 offset:0
    ds_read_b128 v[22:25], v206 offset:4096
    ds_read_b128 v[26:29], v206 offset:8192
    s_add_u32 m0, s37, 12288
    s_add_u32 s42, s35, 0
    buffer_load_dwordx4 v220, s[20:23], s42 offen lds
    s_add_u32 m0, s37, 13312
    s_add_u32 s42, s35, 32768
    buffer_load_dwordx4 v221, s[20:23], s42 offen lds
    s_add_u32 m0, s37, 14336
    s_add_u32 s42, s35, 65536
    buffer_load_dwordx4 v220, s[20:23], s42 offen lds
    s_add_u32 s71, s71, 1
    s_cmp_eq_u32 s71, 8
    s_cselect_b32 s71, 0, s71
    s_add_u32 s72, s72, 1
    s_cmp_eq_u32 s72, 8
    s_cselect_b32 s72, 0, s72
    s_cselect_b32 s76, 8, 0
    s_add_u32 s73, s73, s76
    s_add_u32 s76, s73, s71
    s_mul_i32 s76, s76, 128
    s_add_u32 s35, s75, s76
    s_add_u32 m0, s36, 32768
    s_add_u32 s42, s34, 0
    buffer_load_dwordx4 v200, s[16:19], s42 offen lds
    s_add_u32 m0, s36, 33792
    s_add_u32 s42, s34, 36864
    buffer_load_dwordx4 v200, s[16:19], s42 offen lds
    s_add_u32 m0, s36, 34816
    s_add_u32 s42, s34, 73728
    buffer_load_dwordx4 v200, s[16:19], s42 offen lds
    s_add_u32 m0, s36, 35840
    s_add_u32 s42, s34, 110592
    buffer_load_dwordx4 v200, s[16:19], s42 offen lds
    s_add_u32 s68, s68, 1
    s_cmp_eq_u32 s68, 8
    s_cselect_b32 s68, 0, s68
    s_add_u32 s69, s69, 1
    s_cmp_eq_u32 s69, 8
    s_cselect_b32 s69, 0, s69
    s_cselect_b32 s76, 8, 0
    s_add_u32 s70, s70, s76
    s_add_u32 s76, s70, s68
    s_mul_i32 s76, s76, 589824
    s_add_u32 s34, s74, s76
    s_mov_b32 s40, 4
L_g1_loop:
    ds_read_b64_tr_b16 v[30:31], v204 offset:4096
    ds_read_b64_tr_b16 v[32:33], v204 offset:5120
    ds_read_b64_tr_b16 v[34:35], v205 offset:4096
    ds_read_b64_tr_b16 v[36:37], v205 offset:5120
    ds_read_b128 v[38:41], v207 offset:0
    ds_read_b128 v[42:45], v207 offset:4096
    ds_read_b128 v[46:49], v207 offset:8192
    s_waitcnt lgkmcnt(7)
    v_mfma_f32_32x32x16_bf16 v[100:115], v[10:13], v[18:21], v[100:115]
    v_mfma_f32_32x32x16_bf16 v[116:131], v[10:13], v[22:25], v[116:131]
    v_mfma_f32_32x32x16_bf16 v[132:147], v[10:13], v[26:29], v[132:147]
    v_mfma_f32_32x32x16_bf16 v[148:163], v[14:17], v[18:21], v[148:163]
    v_mfma_f32_32x32x16_bf16 v[164:179], v[14:17], v[22:25], v[164:179]
    v_mfma_f32_32x32x16_bf16 v[180:195], v[14:17], v[26:29], v[180:195]
    s_waitcnt vmcnt(4) lgkmcnt(0)
    s_barrier
    ds_read_b64_tr_b16 v[10:11], v204 offset:16384
    ds_read_b64_tr_b16 v[12:13], v204 offset:17408
    ds_read_b64_tr_b16 v[14:15], v205 offset:16384
    ds_read_b64_tr_b16 v[16:17], v205 offset:17408
    ds_read_b128 v[18:21], v206 offset:12288
    ds_read_b128 v[22:25], v206 offset:16384
    ds_read_b128 v[26:29], v206 offset:20480
    s_waitcnt lgkmcnt(7)
    v_mfma_f32_32x32x16_bf16 v[100:115], v[30:33], v[38:41], v[100:115]
    s_add_u32 m0, s37, 0
    s_add_u32 s42, s35, 0
    buffer_load_dwordx4 v220, s[20:23], s42 offen lds
    s_add_u32 m0, s37, 1024
    s_add_u32 s42, s35, 32768
    buffer_load_dwordx4 v221, s[20:23], s42 offen lds
    v_mfma_f32_32x32x16_bf16 v[116:131], v[30:33], v[42:45], v[116:131]
    s_add_u32 m0, s37, 2048
    s_add_u32 s42, s35, 65536
    buffer_load_dwordx4 v220, s[20:23], s42 offen lds
    s_add_u32 s71, s71, 1
    s_cmp_eq_u32 s71, 8
    s_cselect_b32 s71, 0, s71
    s_add_u32 s72, s72, 1
    s_cmp_eq_u32 s72, 8
    s_cselect_b32 s72, 0, s72
    s_cselect_b32 s76, 8, 0
    s_add_u32 s73, s73, s76
    s_add_u32 s76, s73, s71
    s_mul_i32 s76, s76, 128
    s_add_u32 s35, s75, s76
    v_mfma_f32_32x32x16_bf16 v[132:147], v[30:33], v[46:49], v[132:147]
    s_add_u32 m0, s36, 0
    s_add_u32 s42, s34, 0
    buffer_load_dwordx4 v200, s[16:19], s42 offen lds
    s_add_u32 m0, s36, 1024
    s_add_u32 s42, s34, 36864
    buffer_load_dwordx4 v200, s[16:19], s42 offen lds
    v_mfma_f32_32x32x16_bf16 v[148:163], v[34:37], v[38:41], v[148:163]
    s_add_u32 m0, s36, 2048
    s_add_u32 s42, s34, 73728
    buffer_load_dwordx4 v200, s[16:19], s42 offen lds
    s_add_u32 m0, s36, 3072
    s_add_u32 s42, s34, 110592
    buffer_load_dwordx4 v200, s[16:19], s42 offen lds
    v_mfma_f32_32x32x16_bf16 v[164:179], v[34:37], v[42:45], v[164:179]
    s_add_u32 s68, s68, 1
    s_cmp_eq_u32 s68, 8
    s_cselect_b32 s68, 0, s68
    s_add_u32 s69, s69, 1
    s_cmp_eq_u32 s69, 8
    s_cselect_b32 s69, 0, s69
    s_cselect_b32 s76, 8, 0
    s_add_u32 s70, s70, s76
    s_add_u32 s76, s70, s68
    s_mul_i32 s76, s76, 589824
    s_add_u32 s34, s74, s76
    v_mfma_f32_32x32x16_bf16 v[180:195], v[34:37], v[46:49], v[180:195]
    ds_read_b64_tr_b16 v[30:31], v204 offset:20480
    ds_read_b64_tr_b16 v[32:33], v204 offset:21504
    ds_read_b64_tr_b16 v[34:35], v205 offset:20480
    ds_read_b64_tr_b16 v[36:37], v205 offset:21504
    ds_read_b128 v[38:41], v207 offset:12288
    ds_read_b128 v[42:45], v207 offset:16384
    ds_read_b128 v[46:49], v207 offset:20480
    s_waitcnt lgkmcnt(7)
    v_mfma_f32_32x32x16_bf16 v[100:115], v[10:13], v[18:21], v[100:115]
    v_mfma_f32_32x32x16_bf16 v[116:131], v[10:13], v[22:25], v[116:131]
    v_mfma_f32_32x32x16_bf16 v[132:147], v[10:13], v[26:29], v[132:147]
    v_mfma_f32_32x32x16_bf16 v[148:163], v[14:17], v[18:21], v[148:163]
    v_mfma_f32_32x32x16_bf16 v[164:179], v[14:17], v[22:25], v[164:179]
    v_mfma_f32_32x32x16_bf16 v[180:195], v[14:17], v[26:29], v[180:195]
    s_waitcnt vmcnt(4) lgkmcnt(0)
    s_barrier
    ds_read_b64_tr_b16 v[10:11], v204 offset:32768
    ds_read_b64_tr_b16 v[12:13], v204 offset:33792
    ds_read_b64_tr_b16 v[14:15], v205 offset:32768
    ds_read_b64_tr_b16 v[16:17], v205 offset:33792
    ds_read_b128 v[18:21], v206 offset:0
    ds_read_b128 v[22:25], v206 offset:4096
    ds_read_b128 v[26:29], v206 offset:8192
    s_waitcnt lgkmcnt(7)
    v_mfma_f32_32x32x16_bf16 v[100:115], v[30:33], v[38:41], v[100:115]
    s_add_u32 m0, s37, 12288
    s_add_u32 s42, s35, 0
    buffer_load_dwordx4 v220, s[20:23], s42 offen lds
    s_add_u32 m0, s37, 13312
    s_add_u32 s42, s35, 32768
    buffer_load_dwordx4 v221, s[20:23], s42 offen lds
    v_mfma_f32_32x32x16_bf16 v[116:131], v[30:33], v[42:45], v[116:131]
    s_add_u32 m0, s37, 14336
    s_add_u32 s42, s35, 65536
    buffer_load_dwordx4 v220, s[20:23], s42 offen lds
    s_add_u32 s71, s71, 1
    s_cmp_eq_u32 s71, 8
    s_cselect_b32 s71, 0, s71
    s_add_u32 s72, s72, 1
    s_cmp_eq_u32 s72, 8
    s_cselect_b32 s72, 0, s72
    s_cselect_b32 s76, 8, 0
    s_add_u32 s73, s73, s76
    s_add_u32 s76, s73, s71
    s_mul_i32 s76, s76, 128
    s_add_u32 s35, s75, s76
    v_mfma_f32_32x32x16_bf16 v[132:147], v[30:33], v[46:49], v[132:147]
    s_add_u32 m0, s36, 16384
    s_add_u32 s42, s34, 0
    buffer_load_dwordx4 v200, s[16:19], s42 offen lds
    s_add_u32 m0, s36, 17408
    s_add_u32 s42, s34, 36864
    buffer_load_dwordx4 v200, s[16:19], s42 offen lds
    v_mfma_f32_32x32x16_bf16 v[148:163], v[34:37], v[38:41], v[148:163]
    s_add_u32 m0, s36, 18432
    s_add_u32 s42, s34, 73728
    buffer_load_dwordx4 v200, s[16:19], s42 offen lds
    s_add_u32 m0, s36, 19456
    s_add_u32 s42, s34, 110592
    buffer_load_dwordx4 v200, s[16:19], s42 offen lds
    v_mfma_f32_32x32x16_bf16 v[164:179], v[34:37], v[42:45], v[164:179]
    s_add_u32 s68, s68, 1
    s_cmp_eq_u32 s68, 8
    s_cselect_b32 s68, 0, s68
    s_add_u32 s69, s69, 1
    s_cmp_eq_u32 s69, 8
    s_cselect_b32 s69, 0, s69
    s_cselect_b32 s76, 8, 0
    s_add_u32 s70, s70, s76
    s_add_u32 s76, s70, s68
    s_mul_i32 s76, s76, 589824
    s_add_u32 s34, s74, s76
    v_mfma_f32_32x32x16_bf16 v[180:195], v[34:37], v[46:49], v[180:195]
    ds_read_b64_tr_b16 v[30:31], v204 offset:36864
    ds_read_b64_tr_b16 v[32:33], v204 offset:37888
    ds_read_b64_tr_b16 v[34:35], v205 offset:36864
    ds_read_b64_tr_b16 v[36:37], v205 offset:37888
    ds_read_b128 v[38:41], v207 offset:0
    ds_read_b128 v[42:45], v207 offset:4096
    ds_read_b128 v[46:49], v207 offset:8192
    s_waitcnt lgkmcnt(7)
    v_mfma_f32_32x32x16_bf16 v[100:115], v[10:13], v[18:21], v[100:115]
    v_mfma_f32_32x32x16_bf16 v[116:131], v[10:13], v[22:25], v[116:131]
    v_mfma_f32_32x32x16_bf16 v[132:147], v[10:13], v[26:29], v[132:147]
    v_mfma_f32_32x32x16_bf16 v[148:163], v[14:17], v[18:21], v[148:163]
    v_mfma_f32_32x32x16_bf16 v[164:179], v[14:17], v[22:25], v[164:179]
    v_mfma_f32_32x32x16_bf16 v[180:195], v[14:17], v[26:29], v[180:195]
    s_waitcnt vmcnt(4) lgkmcnt(0)
    s_barrier
    ds_read_b64_tr_b16 v[10:11], v204 offset:0
    ds_read_b64_tr_b16 v[12:13], v204 offset:1024
    ds_read_b64_tr_b16 v[14:15], v205 offset:0
    ds_read_b64_tr_b16 v[16:17], v205 offset:1024
    ds_read_b128 v[18:21], v206 offset:12288
    ds_read_b128 v[22:25], v206 offset:16384
    ds_read_b128 v[26:29], v206 offset:20480
    s_waitcnt lgkmcnt(7)
    v_mfma_f32_32x32x16_bf16 v[100:115], v[30:33], v[38:41], v[100:115]
    s_add_u32 m0, s37, 0
    s_add_u32 s42, s35, 0
    buffer_load_dwordx4 v220, s[20:23], s42 offen lds
    s_add_u32 m0, s37, 1024
    s_add_u32 s42, s35, 32768
    buffer_load_dwordx4 v221, s[20:23], s42 offen lds
    v_mfma_f32_32x32x16_bf16 v[116:131], v[30:33], v[42:45], v[116:131]
    s_add_u32 m0, s37, 2048
    s_add_u32 s42, s35, 65536
    buffer_load_dwordx4 v220, s[20:23], s42 offen lds
    s_add_u32 s71, s71, 1
    s_cmp_eq_u32 s71, 8
    s_cselect_b32 s71, 0, s71
    s_add_u32 s72, s72, 1
    s_cmp_eq_u32 s72, 8
    s_cselect_b32 s72, 0, s72
    s_cselect_b32 s76, 8, 0
    s_add_u32 s73, s73, s76
    s_add_u32 s76, s73, s71
    s_mul_i32 s76, s76, 128
    s_add_u32 s35, s75, s76
    v_mfma_f32_32x32x16_bf16 v[132:147], v[30:33], v[46:49], v[132:147]
    s_add_u32 m0, s36, 32768
    s_add_u32 s42, s34, 0
    buffer_load_dwordx4 v200, s[16:19], s42 offen lds
    s_add_u32 m0, s36, 33792
    s_add_u32 s42, s34, 36864
    buffer_load_dwordx4 v200, s[16:19], s42 offen lds
    v_mfma_f32_32x32x16_bf16 v[148:163], v[34:37], v[38:41], v[148:163]
    s_add_u32 m0, s36, 34816
    s_add_u32 s42, s34, 73728
    buffer_load_dwordx4 v200, s[16:19], s42 offen lds
    s_add_u32 m0, s36, 35840
    s_add_u32 s42, s34, 110592
    buffer_load_dwordx4 v200, s[16:19], s42 offen lds
    v_mfma_f32_32x32x16_bf16 v[164:179], v[34:37], v[42:45], v[164:179]
    s_add_u32 s68, s68, 1
    s_cmp_eq_u32 s68, 8
    s_cselect_b32 s68, 0, s68
    s_add_u32 s69, s69, 1
    s_cmp_eq_u32 s69, 8
    s_cselect_b32 s69, 0, s69
    s_cselect_b32 s76, 8, 0
    s_add_u32 s70, s70, s76
    s_add_u32 s76, s70, s68
    s_mul_i32 s76, s76, 589824
    s_add_u32 s34, s74, s76
    v_mfma_f32_32x32x16_bf16 v[180:195], v[34:37], v[46:49], v[180:195]
    ds_read_b64_tr_b16 v[30:31], v204 offset:4096
    ds_read_b64_tr_b16 v[32:33], v204 offset:5120
    ds_read_b64_tr_b16 v[34:35], v205 offset:4096
    ds_read_b64_tr_b16 v[36:37], v205 offset:5120
    ds_read_b128 v[38:41], v207 offset:12288
    ds_read_b128 v[42:45], v207 offset:16384
    ds_read_b128 v[46:49], v207 offset:20480
    s_waitcnt lgkmcnt(7)
    v_mfma_f32_32x32x16_bf16 v[100:115], v[10:13], v[18:21], v[100:115]
    v_mfma_f32_32x32x16_bf16 v[116:131], v[10:13], v[22:25], v[116:131]
    v_mfma_f32_32x32x16_bf16 v[132:147], v[10:13], v[26:29], v[132:147]
    v_mfma_f32_32x32x16_bf16 v[148:163], v[14:17], v[18:21], v[148:163]
    v_mfma_f32_32x32x16_bf16 v[164:179], v[14:17], v[22:25], v[164:179]
    v_mfma_f32_32x32x16_bf16 v[180:195], v[14:17], v[26:29], v[180:195]
    s_waitcnt vmcnt(4) lgkmcnt(0)
    s_barrier
    ds_read_b64_tr_b16 v[10:11], v204 offset:16384
    ds_read_b64_tr_b16 v[12:13], v204 offset:17408
    ds_read_b64_tr_b16 v[14:15], v205 offset:16384
    ds_read_b64_tr_b16 v[16:17], v205 offset:17408
    ds_read_b128 v[18:21], v206 offset:0
    ds_read_b128 v[22:25], v206 offset:4096
    ds_read_b128 v[26:29], v206 offset:8192
    s_waitcnt lgkmcnt(7)
    v_mfma_f32_32x32x16_bf16 v[100:115], v[30:33], v[38:41], v[100:115]
    s_add_u32 m0, s37, 12288
    s_add_u32 s42, s35, 0
    buffer_load_dwordx4 v220, s[20:23], s42 offen lds
    s_add_u32 m0, s37, 13312
    s_add_u32 s42, s35, 32768
    buffer_load_dwordx4 v221, s[20:23], s42 offen lds
    v_mfma_f32_32x32x16_bf16 v[116:131], v[30:33], v[42:45], v[116:131]
    s_add_u32 m0, s37, 14336
    s_add_u32 s42, s35, 65536
    buffer_load_dwordx4 v220, s[20:23], s42 offen lds
    s_add_u32 s71, s71, 1
    s_cmp_eq_u32 s71, 8
    s_cselect_b32 s71, 0, s71
    s_add_u32 s72, s72, 1
    s_cmp_eq_u32 s72, 8
    s_cselect_b32 s72, 0, s72
    s_cselect_b32 s76, 8, 0
    s_add_u32 s73, s73, s76
    s_add_u32 s76, s73, s71
    s_mul_i32 s76, s76, 128
    s_add_u32 s35, s75, s76
    v_mfma_f32_32x32x16_bf16 v[132:147], v[30:33], v[46:49], v[132:147]
    s_add_u32 m0, s36, 0
    s_add_u32 s42, s34, 0
    buffer_load_dwordx4 v200, s[16:19], s42 offen lds
    s_add_u32 m0, s36, 1024
    s_add_u32 s42, s34, 36864
    buffer_load_dwordx4 v200, s[16:19], s42 offen lds
    v_mfma_f32_32x32x16_bf16 v[148:163], v[34:37], v[38:41], v[148:163]
    s_add_u32 m0, s36, 2048
    s_add_u32 s42, s34, 73728
    buffer_load_dwordx4 v200, s[16:19], s42 offen lds
    s_add_u32 m0, s36, 3072
    s_add_u32 s42, s34, 110592
    buffer_load_dwordx4 v200, s[16:19], s42 offen lds
    v_mfma_f32_32x32x16_bf16 v[164:179], v[34:37], v[42:45], v[164:179]
    s_add_u32 s68, s68, 1
    s_cmp_eq_u32 s68, 8
    s_cselect_b32 s68, 0, s68
    s_add_u32 s69, s69, 1
    s_cmp_eq_u32 s69, 8
    s_cselect_b32 s69, 0, s69
    s_cselect_b32 s76, 8, 0
    s_add_u32 s70, s70, s76
    s_add_u32 s76, s70, s68
    s_mul_i32 s76, s76, 589824
    s_add_u32 s34, s74, s76
    v_mfma_f32_32x32x16_bf16 v[180:195], v[34:37], v[46:49], v[180:195]
    ds_read_b64_tr_b16 v[30:31], v204 offset:20480
    ds_read_b64_tr_b16 v[32:33], v204 offset:21504
    ds_read_b64_tr_b16 v[34:35], v205 offset:20480
    ds_read_b64_tr_b16 v[36:37], v205 offset:21504
    ds_read_b128 v[38:41], v207 offset:0
    ds_read_b128 v[42:45], v207 offset:4096
    ds_read_b128 v[46:49], v207 offset:8192
    s_waitcnt lgkmcnt(7)
    v_mfma_f32_32x32x16_bf16 v[100:115], v[10:13], v[18:21], v[100:115]
    v_mfma_f32_32x32x16_bf16 v[116:131], v[10:13], v[22:25], v[116:131]
    v_mfma_f32_32x32x16_bf16 v[132:147], v[10:13], v[26:29], v[132:147]
    v_mfma_f32_32x32x16_bf16 v[148:163], v[14:17], v[18:21], v[148:163]
    v_mfma_f32_32x32x16_bf16 v[164:179], v[14:17], v[22:25], v[164:179]
    v_mfma_f32_32x32x16_bf16 v[180:195], v[14:17], v[26:29], v[180:195]
    s_waitcnt vmcnt(4) lgkmcnt(0)
    s_barrier
    ds_read_b64_tr_b16 v[10:11], v204 offset:32768
    ds_read_b64_tr_b16 v[12:13], v204 offset:33792
    ds_read_b64_tr_b16 v[14:15], v205 offset:32768
    ds_read_b64_tr_b16 v[16:17], v205 offset:33792
    ds_read_b128 v[18:21], v206 offset:12288
    ds_read_b128 v[22:25], v206 offset:16384
    ds_read_b128 v[26:29], v206 offset:20480
    s_waitcnt lgkmcnt(7)
    v_mfma_f32_32x32x16_bf16 v[100:115], v[30:33], v[38:41], v[100:115]
    s_add_u32 m0, s37, 0
    s_add_u32 s42, s35, 0
    buffer_load_dwordx4 v220, s[20:23], s42 offen lds
    s_add_u32 m0, s37, 1024
    s_add_u32 s42, s35, 32768
    buffer_load_dwordx4 v221, s[20:23], s42 offen lds
    v_mfma_f32_32x32x16_bf16 v[116:131], v[30:33], v[42:45], v[116:131]
    s_add_u32 m0, s37, 2048
    s_add_u32 s42, s35, 65536
    buffer_load_dwordx4 v220, s[20:23], s42 offen lds
    s_add_u32 s71, s71, 1
    s_cmp_eq_u32 s71, 8
    s_cselect_b32 s71, 0, s71
    s_add_u32 s72, s72, 1
    s_cmp_eq_u32 s72, 8
    s_cselect_b32 s72, 0, s72
    s_cselect_b32 s76, 8, 0
    s_add_u32 s73, s73, s76
    s_add_u32 s76, s73, s71
    s_mul_i32 s76, s76, 128
    s_add_u32 s35, s75, s76
    v_mfma_f32_32x32x16_bf16 v[132:147], v[30:33], v[46:49], v[132:147]
    s_add_u32 m0, s36, 16384
    s_add_u32 s42, s34, 0
    buffer_load_dwordx4 v200, s[16:19], s42 offen lds
    s_add_u32 m0, s36, 17408
    s_add_u32 s42, s34, 36864
    buffer_load_dwordx4 v200, s[16:19], s42 offen lds
    v_mfma_f32_32x32x16_bf16 v[148:163], v[34:37], v[38:41], v[148:163]
    s_add_u32 m0, s36, 18432
    s_add_u32 s42, s34, 73728
    buffer_load_dwordx4 v200, s[16:19], s42 offen lds
    s_add_u32 m0, s36, 19456
    s_add_u32 s42, s34, 110592
    buffer_load_dwordx4 v200, s[16:19], s42 offen lds
    v_mfma_f32_32x32x16_bf16 v[164:179], v[34:37], v[42:45], v[164:179]
    s_add_u32 s68, s68, 1
    s_cmp_eq_u32 s68, 8
    s_cselect_b32 s68, 0, s68
    s_add_u32 s69, s69, 1
    s_cmp_eq_u32 s69, 8
    s_cselect_b32 s69, 0, s69
    s_cselect_b32 s76, 8, 0
    s_add_u32 s70, s70, s76
    s_add_u32 s76, s70, s68
    s_mul_i32 s76, s76, 589824
    s_add_u32 s34, s74, s76
    v_mfma_f32_32x32x16_bf16 v[180:195], v[34:37], v[46:49], v[180:195]
    ds_read_b64_tr_b16 v[30:31], v204 offset:36864
    ds_read_b64_tr_b16 v[32:33], v204 offset:37888
    ds_read_b64_tr_b16 v[34:35], v205 offset:36864
    ds_read_b64_tr_b16 v[36:37], v205 offset:37888
    ds_read_b128 v[38:41], v207 offset:12288
    ds_read_b128 v[42:45], v207 offset:16384
    ds_read_b128 v[46:49], v207 offset:20480
    s_waitcnt lgkmcnt(7)
    v_mfma_f32_32x32x16_bf16 v[100:115], v[10:13], v[18:21], v[100:115]
    v_mfma_f32_32x32x16_bf16 v[116:131], v[10:13], v[22:25], v[116:131]
    v_mfma_f32_32x32x16_bf16 v[132:147], v[10:13], v[26:29], v[132:147]
    v_mfma_f32_32x32x16_bf16 v[148:163], v[14:17], v[18:21], v[148:163]
    v_mfma_f32_32x32x16_bf16 v[164:179], v[14:17], v[22:25], v[164:179]
    v_mfma_f32_32x32x16_bf16 v[180:195], v[14:17], v[26:29], v[180:195]
    s_waitcnt vmcnt(4) lgkmcnt(0)
    s_barrier
    ds_read_b64_tr_b16 v[10:11], v204 offset:0
    ds_read_b64_tr_b16 v[12:13], v204 offset:1024
    ds_read_b64_tr_b16 v[14:15], v205 offset:0
    ds_read_b64_tr_b16 v[16:17], v205 offset:1024
    ds_read_b128 v[18:21], v206 offset:0
    ds_read_b128 v[22:25], v206 offset:4096
    ds_read_b128 v[26:29], v206 offset:8192
    s_waitcnt lgkmcnt(7)
    v_mfma_f32_32x32x16_bf16 v[100:115], v[30:33], v[38:41], v[100:115]
    s_add_u32 m0, s37, 12288
    s_add_u32 s42, s35, 0
    buffer_load_dwordx4 v220, s[20:23], s42 offen lds
    s_add_u32 m0, s37, 13312
    s_add_u32 s42, s35, 32768
    buffer_load_dwordx4 v221, s[20:23], s42 offen lds
    v_mfma_f32_32x32x16_bf16 v[116:131], v[30:33], v[42:45], v[116:131]
    s_add_u32 m0, s37, 14336
    s_add_u32 s42, s35, 65536
    buffer_load_dwordx4 v220, s[20:23], s42 offen lds
    s_add_u32 s71, s71, 1
    s_cmp_eq_u32 s71, 8
    s_cselect_b32 s71, 0, s71
    s_add_u32 s72, s72, 1
    s_cmp_eq_u32 s72, 8
    s_cselect_b32 s72, 0, s72
    s_cselect_b32 s76, 8, 0
    s_add_u32 s73, s73, s76
    s_add_u32 s76, s73, s71
    s_mul_i32 s76, s76, 128
    s_add_u32 s35, s75, s76
    v_mfma_f32_32x32x16_bf16 v[132:147], v[30:33], v[46:49], v[132:147]
    s_add_u32 m0, s36, 32768
    s_add_u32 s42, s34, 0
    buffer_load_dwordx4 v200, s[16:19], s42 offen lds
    s_add_u32 m0, s36, 33792
    s_add_u32 s42, s34, 36864
    buffer_load_dwordx4 v200, s[16:19], s42 offen lds
    v_mfma_f32_32x32x16_bf16 v[148:163], v[34:37], v[38:41], v[148:163]
    s_add_u32 m0, s36, 34816
    s_add_u32 s42, s34, 73728
    buffer_load_dwordx4 v200, s[16:19], s42 offen lds
    s_add_u32 m0, s36, 35840
    s_add_u32 s42, s34, 110592
    buffer_load_dwordx4 v200, s[16:19], s42 offen lds
    v_mfma_f32_32x32x16_bf16 v[164:179], v[34:37], v[42:45], v[164:179]
    s_add_u32 s68, s68, 1
    s_cmp_eq_u32 s68, 8
    s_cselect_b32 s68, 0, s68
    s_add_u32 s69, s69, 1
    s_cmp_eq_u32 s69, 8
    s_cselect_b32 s69, 0, s69
    s_cselect_b32 s76, 8, 0
    s_add_u32 s70, s70, s76
    s_add_u32 s76, s70, s68
    s_mul_i32 s76, s76, 589824
    s_add_u32 s34, s74, s76
    v_mfma_f32_32x32x16_bf16 v[180:195], v[34:37], v[46:49], v[180:195]
    s_sub_u32 s40, s40, 1
    s_cmp_lg_u32 s40, 0
    s_cbranch_scc1 L_g1_loop
    ds_read_b64_tr_b16 v[30:31], v204 offset:4096
    ds_read_b64_tr_b16 v[32:33], v204 offset:5120
    ds_read_b64_tr_b16 v[34:35], v205 offset:4096
    ds_read_b64_tr_b16 v[36:37], v205 offset:5120
    ds_read_b128 v[38:41], v207 offset:0
    ds_read_b128 v[42:45], v207 offset:4096
    ds_read_b128 v[46:49], v207 offset:8192
    s_waitcnt lgkmcnt(7)
    v_mfma_f32_32x32x16_bf16 v[100:115], v[10:13], v[18:21], v[100:115]
    v_mfma_f32_32x32x16_bf16 v[116:131], v[10:13], v[22:25], v[116:131]
    v_mfma_f32_32x32x16_bf16 v[132:147], v[10:13], v[26:29], v[132:147]
    v_mfma_f32_32x32x16_bf16 v[148:163], v[14:17], v[18:21], v[148:163]
    v_mfma_f32_32x32x16_bf16 v[164:179], v[14:17], v[22:25], v[164:179]
    v_mfma_f32_32x32x16_bf16 v[180:195], v[14:17], v[26:29], v[180:195]
    s_waitcnt vmcnt(4) lgkmcnt(0)
    s_barrier
    ds_read_b64_tr_b16 v[10:11], v204 offset:16384
    ds_read_b64_tr_b16 v[12:13], v204 offset:17408
    ds_read_b64_tr_b16 v[14:15], v205 offset:16384
    ds_read_b64_tr_b16 v[16:17], v205 offset:17408
    ds_read_b128 v[18:21], v206 offset:12288
    ds_read_b128 v[22:25], v206 offset:16384
    ds_read_b128 v[26:29], v206 offset:20480
    s_waitcnt lgkmcnt(7)
    v_mfma_f32_32x32x16_bf16 v[100:115], v[30:33], v[38:41], v[100:115]
    s_add_u32 m0, s37, 0
    s_add_u32 s42, s35, 0
    buffer_load_dwordx4 v220, s[20:23], s42 offen lds
    s_add_u32 m0, s37, 1024
    s_add_u32 s42, s35, 32768
    buffer_load_dwordx4 v221, s[20:23], s42 offen lds
    v_mfma_f32_32x32x16_bf16 v[116:131], v[30:33], v[42:45], v[116:131]
    s_add_u32 m0, s37, 2048
    s_add_u32 s42, s35, 65536
    buffer_load_dwordx4 v220, s[20:23], s42 offen lds
    s_add_u32 s71, s71, 1
    s_cmp_eq_u32 s71, 8
    s_cselect_b32 s71, 0, s71
    s_add_u32 s72, s72, 1
    s_cmp_eq_u32 s72, 8
    s_cselect_b32 s72, 0, s72
    s_cselect_b32 s76, 8, 0
    s_add_u32 s73, s73, s76
    s_add_u32 s76, s73, s71
    s_mul_i32 s76, s76, 128
    s_add_u32 s35, s75, s76
    v_mfma_f32_32x32x16_bf16 v[132:147], v[30:33], v[46:49], v[132:147]
    s_add_u32 m0, s36, 0
    s_add_u32 s42, s34, 0
    buffer_load_dwordx4 v200, s[16:19], s42 offen lds
    s_add_u32 m0, s36, 1024
    s_add_u32 s42, s34, 36864
    buffer_load_dwordx4 v200, s[16:19], s42 offen lds
    v_mfma_f32_32x32x16_bf16 v[148:163], v[34:37], v[38:41], v[148:163]
    s_add_u32 m0, s36, 2048
    s_add_u32 s42, s34, 73728
    buffer_load_dwordx4 v200, s[16:19], s42 offen lds
    s_add_u32 m0, s36, 3072
    s_add_u32 s42, s34, 110592
    buffer_load_dwordx4 v200, s[16:19], s42 offen lds
    v_mfma_f32_32x32x16_bf16 v[164:179], v[34:37], v[42:45], v[164:179]
    s_add_u32 s68, s68, 1
    s_cmp_eq_u32 s68, 8
    s_cselect_b32 s68, 0, s68
    s_add_u32 s69, s69, 1
    s_cmp_eq_u32 s69, 8
    s_cselect_b32 s69, 0, s69
    s_cselect_b32 s76, 8, 0
    s_add_u32 s70, s70, s76
    s_add_u32 s76, s70, s68
    s_mul_i32 s76, s76, 589824
    s_add_u32 s34, s74, s76
    v_mfma_f32_32x32x16_bf16 v[180:195], v[34:37], v[46:49], v[180:195]
    ds_read_b64_tr_b16 v[30:31], v204 offset:20480
    ds_read_b64_tr_b16 v[32:33], v204 offset:21504
    ds_read_b64_tr_b16 v[34:35], v205 offset:20480
    ds_read_b64_tr_b16 v[36:37], v205 offset:21504
    ds_read_b128 v[38:41], v207 offset:12288
    ds_read_b128 v[42:45], v207 offset:16384
    ds_read_b128 v[46:49], v207 offset:20480
    s_waitcnt lgkmcnt(7)
    v_mfma_f32_32x32x16_bf16 v[100:115], v[10:13], v[18:21], v[100:115]
    v_mfma_f32_32x32x16_bf16 v[116:131], v[10:13], v[22:25], v[116:131]
    v_mfma_f32_32x32x16_bf16 v[132:147], v[10:13], v[26:29], v[132:147]
    v_mfma_f32_32x32x16_bf16 v[148:163], v[14:17], v[18:21], v[148:163]
    v_mfma_f32_32x32x16_bf16 v[164:179], v[14:17], v[22:25], v[164:179]
    v_mfma_f32_32x32x16_bf16 v[180:195], v[14:17], v[26:29], v[180:195]
    s_waitcnt vmcnt(4) lgkmcnt(0)
    s_barrier
    ds_read_b64_tr_b16 v[10:11], v204 offset:32768
    ds_read_b64_tr_b16 v[12:13], v204 offset:33792
    ds_read_b64_tr_b16 v[14:15], v205 offset:32768
    ds_read_b64_tr_b16 v[16:17], v205 offset:33792
    ds_read_b128 v[18:21], v206 offset:0
    ds_read_b128 v[22:25], v206 offset:4096
    ds_read_b128 v[26:29], v206 offset:8192
    s_waitcnt lgkmcnt(7)
    v_mfma_f32_32x32x16_bf16 v[100:115], v[30:33], v[38:41], v[100:115]
    s_add_u32 m0, s37, 12288
    s_add_u32 s42, s35, 0
    buffer_load_dwordx4 v220, s[20:23], s42 offen lds
    s_add_u32 m0, s37, 13312
    s_add_u32 s42, s35, 32768
    buffer_load_dwordx4 v221, s[20:23], s42 offen lds
    v_mfma_f32_32x32x16_bf16 v[116:131], v[30:33], v[42:45], v[116:131]
    s_add_u32 m0, s37, 14336
    s_add_u32 s42, s35, 65536
    buffer_load_dwordx4 v220, s[20:23], s42 offen lds
    s_add_u32 s71, s71, 1
    s_cmp_eq_u32 s71, 8
    s_cselect_b32 s71, 0, s71
    s_add_u32 s72, s72, 1
    s_cmp_eq_u32 s72, 8
    s_cselect_b32 s72, 0, s72
    s_cselect_b32 s76, 8, 0
    s_add_u32 s73, s73, s76
    s_add_u32 s76, s73, s71
    s_mul_i32 s76, s76, 128
    s_add_u32 s35, s75, s76
    v_mfma_f32_32x32x16_bf16 v[132:147], v[30:33], v[46:49], v[132:147]
    s_add_u32 m0, s36, 16384
    s_add_u32 s42, s34, 0
    buffer_load_dwordx4 v200, s[16:19], s42 offen lds
    s_add_u32 m0, s36, 17408
    s_add_u32 s42, s34, 36864
    buffer_load_dwordx4 v200, s[16:19], s42 offen lds
    v_mfma_f32_32x32x16_bf16 v[148:163], v[34:37], v[38:41], v[148:163]
    s_add_u32 m0, s36, 18432
    s_add_u32 s42, s34, 73728
    buffer_load_dwordx4 v200, s[16:19], s42 offen lds
    s_add_u32 m0, s36, 19456
    s_add_u32 s42, s34, 110592
    buffer_load_dwordx4 v200, s[16:19], s42 offen lds
    v_mfma_f32_32x32x16_bf16 v[164:179], v[34:37], v[42:45], v[164:179]
    s_add_u32 s68, s68, 1
    s_cmp_eq_u32 s68, 8
    s_cselect_b32 s68, 0, s68
    s_add_u32 s69, s69, 1
    s_cmp_eq_u32 s69, 8
    s_cselect_b32 s69, 0, s69
    s_cselect_b32 s76, 8, 0
    s_add_u32 s70, s70, s76
    s_add_u32 s76, s70, s68
    s_mul_i32 s76, s76, 589824
    s_add_u32 s34, s74, s76
    v_mfma_f32_32x32x16_bf16 v[180:195], v[34:37], v[46:49], v[180:195]
    ds_read_b64_tr_b16 v[30:31], v204 offset:36864
    ds_read_b64_tr_b16 v[32:33], v204 offset:37888
    ds_read_b64_tr_b16 v[34:35], v205 offset:36864
    ds_read_b64_tr_b16 v[36:37], v205 offset:37888
    ds_read_b128 v[38:41], v207 offset:0
    ds_read_b128 v[42:45], v207 offset:4096
    ds_read_b128 v[46:49], v207 offset:8192
    s_waitcnt lgkmcnt(7)
    v_mfma_f32_32x32x16_bf16 v[100:115], v[10:13], v[18:21], v[100:115]
    v_mfma_f32_32x32x16_bf16 v[116:131], v[10:13], v[22:25], v[116:131]
    v_mfma_f32_32x32x16_bf16 v[132:147], v[10:13], v[26:29], v[132:147]
    v_mfma_f32_32x32x16_bf16 v[148:163], v[14:17], v[18:21], v[148:163]
    v_mfma_f32_32x32x16_bf16 v[164:179], v[14:17], v[22:25], v[164:179]
    v_mfma_f32_32x32x16_bf16 v[180:195], v[14:17], v[26:29], v[180:195]
    s_waitcnt vmcnt(4) lgkmcnt(0)
    s_barrier
    ds_read_b64_tr_b16 v[10:11], v204 offset:0
    ds_read_b64_tr_b16 v[12:13], v204 offset:1024
    ds_read_b64_tr_b16 v[14:15], v205 offset:0
    ds_read_b64_tr_b16 v[16:17], v205 offset:1024
    ds_read_b128 v[18:21], v206 offset:12288
    ds_read_b128 v[22:25], v206 offset:16384
    ds_read_b128 v[26:29], v206 offset:20480
    s_waitcnt lgkmcnt(7)
    v_mfma_f32_32x32x16_bf16 v[100:115], v[30:33], v[38:41], v[100:115]
    s_add_u32 m0, s37, 0
    s_add_u32 s42, s35, 0
    buffer_load_dwordx4 v220, s[20:23], s42 offen lds
    s_add_u32 m0, s37, 1024
    s_add_u32 s42, s35, 32768
    buffer_load_dwordx4 v221, s[20:23], s42 offen lds
    v_mfma_f32_32x32x16_bf16 v[116:131], v[30:33], v[42:45], v[116:131]
    s_add_u32 m0, s37, 2048
    s_add_u32 s42, s35, 65536
    buffer_load_dwordx4 v220, s[20:23], s42 offen lds
    s_add_u32 s71, s71, 1
    s_cmp_eq_u32 s71, 8
    s_cselect_b32 s71, 0, s71
    s_add_u32 s72, s72, 1
    s_cmp_eq_u32 s72, 8
    s_cselect_b32 s72, 0, s72
    s_cselect_b32 s76, 8, 0
    s_add_u32 s73, s73, s76
    s_add_u32 s76, s73, s71
    s_mul_i32 s76, s76, 128
    s_add_u32 s35, s75, s76
    v_mfma_f32_32x32x16_bf16 v[132:147], v[30:33], v[46:49], v[132:147]
    s_add_u32 m0, s36, 32768
    s_add_u32 s42, s34, 0
    buffer_load_dwordx4 v200, s[16:19], s42 offen lds
    s_add_u32 m0, s36, 33792
    s_add_u32 s42, s34, 36864
    buffer_load_dwordx4 v200, s[16:19], s42 offen lds
    v_mfma_f32_32x32x16_bf16 v[148:163], v[34:37], v[38:41], v[148:163]
    s_add_u32 m0, s36, 34816
    s_add_u32 s42, s34, 73728
    buffer_load_dwordx4 v200, s[16:19], s42 offen lds
    s_add_u32 m0, s36, 35840
    s_add_u32 s42, s34, 110592
    buffer_load_dwordx4 v200, s[16:19], s42 offen lds
    v_mfma_f32_32x32x16_bf16 v[164:179], v[34:37], v[42:45], v[164:179]
    s_add_u32 s68, s68, 1
    s_cmp_eq_u32 s68, 8
    s_cselect_b32 s68, 0, s68
    s_add_u32 s69, s69, 1
    s_cmp_eq_u32 s69, 8
    s_cselect_b32 s69, 0, s69
    s_cselect_b32 s76, 8, 0
    s_add_u32 s70, s70, s76
    s_add_u32 s76, s70, s68
    s_mul_i32 s76, s76, 589824
    s_add_u32 s34, s74, s76
    v_mfma_f32_32x32x16_bf16 v[180:195], v[34:37], v[46:49], v[180:195]
    ds_read_b64_tr_b16 v[30:31], v204 offset:4096
    ds_read_b64_tr_b16 v[32:33], v204 offset:5120
    ds_read_b64_tr_b16 v[34:35], v205 offset:4096
    ds_read_b64_tr_b16 v[36:37], v205 offset:5120
    ds_read_b128 v[38:41], v207 offset:12288
    ds_read_b128 v[42:45], v207 offset:16384
    ds_read_b128 v[46:49], v207 offset:20480
    s_waitcnt lgkmcnt(7)
    v_mfma_f32_32x32x16_bf16 v[100:115], v[10:13], v[18:21], v[100:115]
    v_mfma_f32_32x32x16_bf16 v[116:131], v[10:13], v[22:25], v[116:131]
    v_mfma_f32_32x32x16_bf16 v[132:147], v[10:13], v[26:29], v[132:147]
    v_mfma_f32_32x32x16_bf16 v[148:163], v[14:17], v[18:21], v[148:163]
    v_mfma_f32_32x32x16_bf16 v[164:179], v[14:17], v[22:25], v[164:179]
    v_mfma_f32_32x32x16_bf16 v[180:195], v[14:17], v[26:29], v[180:195]
    s_waitcnt vmcnt(4) lgkmcnt(0)
    s_barrier
    ds_read_b64_tr_b16 v[10:11], v204 offset:16384
    ds_read_b64_tr_b16 v[12:13], v204 offset:17408
    ds_read_b64_tr_b16 v[14:15], v205 offset:16384
    ds_read_b64_tr_b16 v[16:17], v205 offset:17408
    ds_read_b128 v[18:21], v206 offset:0
    ds_read_b128 v[22:25], v206 offset:4096
    ds_read_b128 v[26:29], v206 offset:8192
    s_waitcnt lgkmcnt(7)
    v_mfma_f32_32x32x16_bf16 v[100:115], v[30:33], v[38:41], v[100:115]
    s_add_u32 m0, s37, 12288
    s_add_u32 s42, s35, 0
    buffer_load_dwordx4 v220, s[20:23], s42 offen lds
    s_add_u32 m0, s37, 13312
    s_add_u32 s42, s35, 32768
    buffer_load_dwordx4 v221, s[20:23], s42 offen lds
    v_mfma_f32_32x32x16_bf16 v[116:131], v[30:33], v[42:45], v[116:131]
    s_add_u32 m0, s37, 14336
    s_add_u32 s42, s35, 65536
    buffer_load_dwordx4 v220, s[20:23], s42 offen lds
    s_add_u32 s71, s71, 1
    s_cmp_eq_u32 s71, 8
    s_cselect_b32 s71, 0, s71
    s_add_u32 s72, s72, 1
    s_cmp_eq_u32 s72, 8
    s_cselect_b32 s72, 0, s72
    s_cselect_b32 s76, 8, 0
    s_add_u32 s73, s73, s76
    s_add_u32 s76, s73, s71
    s_mul_i32 s76, s76, 128
    s_add_u32 s35, s75, s76
    v_mfma_f32_32x32x16_bf16 v[132:147], v[30:33], v[46:49], v[132:147]
    s_add_u32 m0, s36, 0
    s_add_u32 s42, s34, 0
    buffer_load_dwordx4 v200, s[16:19], s42 offen lds
    s_add_u32 m0, s36, 1024
    s_add_u32 s42, s34, 36864
    buffer_load_dwordx4 v200, s[16:19], s42 offen lds
    v_mfma_f32_32x32x16_bf16 v[148:163], v[34:37], v[38:41], v[148:163]
    s_add_u32 m0, s36, 2048
    s_add_u32 s42, s34, 73728
    buffer_load_dwordx4 v200, s[16:19], s42 offen lds
    s_add_u32 m0, s36, 3072
    s_add_u32 s42, s34, 110592
    buffer_load_dwordx4 v200, s[16:19], s42 offen lds
    v_mfma_f32_32x32x16_bf16 v[164:179], v[34:37], v[42:45], v[164:179]
    s_add_u32 s68, s68, 1
    s_cmp_eq_u32 s68, 8
    s_cselect_b32 s68, 0, s68
    s_add_u32 s69, s69, 1
    s_cmp_eq_u32 s69, 8
    s_cselect_b32 s69, 0, s69
    s_cselect_b32 s76, 8, 0
    s_add_u32 s70, s70, s76
    s_add_u32 s76, s70, s68
    s_mul_i32 s76, s76, 589824
    s_add_u32 s34, s74, s76
    v_mfma_f32_32x32x16_bf16 v[180:195], v[34:37], v[46:49], v[180:195]
    ds_read_b64_tr_b16 v[30:31], v204 offset:20480
    ds_read_b64_tr_b16 v[32:33], v204 offset:21504
    ds_read_b64_tr_b16 v[34:35], v205 offset:20480
    ds_read_b64_tr_b16 v[36:37], v205 offset:21504
    ds_read_b128 v[38:41], v207 offset:0
    ds_read_b128 v[42:45], v207 offset:4096
    ds_read_b128 v[46:49], v207 offset:8192
    s_waitcnt lgkmcnt(7)
    v_mfma_f32_32x32x16_bf16 v[100:115], v[10:13], v[18:21], v[100:115]
    v_mfma_f32_32x32x16_bf16 v[116:131], v[10:13], v[22:25], v[116:131]
    v_mfma_f32_32x32x16_bf16 v[132:147], v[10:13], v[26:29], v[132:147]
    v_mfma_f32_32x32x16_bf16 v[148:163], v[14:17], v[18:21], v[148:163]
    v_mfma_f32_32x32x16_bf16 v[164:179], v[14:17], v[22:25], v[164:179]
    v_mfma_f32_32x32x16_bf16 v[180:195], v[14:17], v[26:29], v[180:195]
    s_waitcnt vmcnt(4) lgkmcnt(0)
    s_barrier
    ds_read_b64_tr_b16 v[10:11], v204 offset:32768
    ds_read_b64_tr_b16 v[12:13], v204 offset:33792
    ds_read_b64_tr_b16 v[14:15], v205 offset:32768
    ds_read_b64_tr_b16 v[16:17], v205 offset:33792
    ds_read_b128 v[18:21], v206 offset:12288
    ds_read_b128 v[22:25], v206 offset:16384
    ds_read_b128 v[26:29], v206 offset:20480
    s_waitcnt lgkmcnt(7)
    v_mfma_f32_32x32x16_bf16 v[100:115], v[30:33], v[38:41], v[100:115]
    s_add_u32 m0, s37, 0
    s_add_u32 s42, s35, 0
    buffer_load_dwordx4 v220, s[20:23], s42 offen lds
    s_add_u32 m0, s37, 1024
    s_add_u32 s42, s35, 32768
    buffer_load_dwordx4 v221, s[20:23], s42 offen lds
    v_mfma_f32_32x32x16_bf16 v[116:131], v[30:33], v[42:45], v[116:131]
    s_add_u32 m0, s37, 2048
    s_add_u32 s42, s35, 65536
    buffer_load_dwordx4 v220, s[20:23], s42 offen lds
    s_add_u32 s71, s71, 1
    s_cmp_eq_u32 s71, 8
    s_cselect_b32 s71, 0, s71
    s_add_u32 s72, s72, 1
    s_cmp_eq_u32 s72, 8
    s_cselect_b32 s72, 0, s72
    s_cselect_b32 s76, 8, 0
    s_add_u32 s73, s73, s76
    s_add_u32 s76, s73, s71
    s_mul_i32 s76, s76, 128
    s_add_u32 s35, s75, s76
    v_mfma_f32_32x32x16_bf16 v[132:147], v[30:33], v[46:49], v[132:147]
    s_add_u32 m0, s36, 16384
    s_add_u32 s42, s34, 0
    buffer_load_dwordx4 v200, s[16:19], s42 offen lds
    s_add_u32 m0, s36, 17408
    s_add_u32 s42, s34, 36864
    buffer_load_dwordx4 v200, s[16:19], s42 offen lds
    v_mfma_f32_32x32x16_bf16 v[148:163], v[34:37], v[38:41], v[148:163]
    s_add_u32 m0, s36, 18432
    s_add_u32 s42, s34, 73728
    buffer_load_dwordx4 v200, s[16:19], s42 offen lds
    s_add_u32 m0, s36, 19456
    s_add_u32 s42, s34, 110592
    buffer_load_dwordx4 v200, s[16:19], s42 offen lds
    v_mfma_f32_32x32x16_bf16 v[164:179], v[34:37], v[42:45], v[164:179]
    s_add_u32 s68, s68, 1
    s_cmp_eq_u32 s68, 8
    s_cselect_b32 s68, 0, s68
    s_add_u32 s69, s69, 1
    s_cmp_eq_u32 s69, 8
    s_cselect_b32 s69, 0, s69
    s_cselect_b32 s76, 8, 0
    s_add_u32 s70, s70, s76
    s_add_u32 s76, s70, s68
    s_mul_i32 s76, s76, 589824
    s_add_u32 s34, s74, s76
    v_mfma_f32_32x32x16_bf16 v[180:195], v[34:37], v[46:49], v[180:195]
    ds_read_b64_tr_b16 v[30:31], v204 offset:36864
    ds_read_b64_tr_b16 v[32:33], v204 offset:37888
    ds_read_b64_tr_b16 v[34:35], v205 offset:36864
    ds_read_b64_tr_b16 v[36:37], v205 offset:37888
    ds_read_b128 v[38:41], v207 offset:12288
    ds_read_b128 v[42:45], v207 offset:16384
    ds_read_b128 v[46:49], v207 offset:20480
    s_waitcnt lgkmcnt(7)
    v_mfma_f32_32x32x16_bf16 v[100:115], v[10:13], v[18:21], v[100:115]
    v_mfma_f32_32x32x16_bf16 v[116:131], v[10:13], v[22:25], v[116:131]
    v_mfma_f32_32x32x16_bf16 v[132:147], v[10:13], v[26:29], v[132:147]
    v_mfma_f32_32x32x16_bf16 v[148:163], v[14:17], v[18:21], v[148:163]
    v_mfma_f32_32x32x16_bf16 v[164:179], v[14:17], v[22:25], v[164:179]
    v_mfma_f32_32x32x16_bf16 v[180:195], v[14:17], v[26:29], v[180:195]
    s_waitcnt vmcnt(4) lgkmcnt(0)
    s_barrier
    ds_read_b64_tr_b16 v[10:11], v204 offset:0
    ds_read_b64_tr_b16 v[12:13], v204 offset:1024
    ds_read_b64_tr_b16 v[14:15], v205 offset:0
    ds_read_b64_tr_b16 v[16:17], v205 offset:1024
    ds_read_b128 v[18:21], v206 offset:0
    ds_read_b128 v[22:25], v206 offset:4096
    ds_read_b128 v[26:29], v206 offset:8192
    s_waitcnt lgkmcnt(7)
    v_mfma_f32_32x32x16_bf16 v[100:115], v[30:33], v[38:41], v[100:115]
    s_add_u32 m0, s37, 12288
    s_add_u32 s42, s35, 0
    buffer_load_dwordx4 v220, s[20:23], s42 offen lds
    s_add_u32 m0, s37, 13312
    s_add_u32 s42, s35, 32768
    buffer_load_dwordx4 v221, s[20:23], s42 offen lds
    v_mfma_f32_32x32x16_bf16 v[116:131], v[30:33], v[42:45], v[116:131]
    s_add_u32 m0, s37, 14336
    s_add_u32 s42, s35, 65536
    buffer_load_dwordx4 v220, s[20:23], s42 offen lds
    s_add_u32 s71, s71, 1
    s_cmp_eq_u32 s71, 8
    s_cselect_b32 s71, 0, s71
    s_add_u32 s72, s72, 1
    s_cmp_eq_u32 s72, 8
    s_cselect_b32 s72, 0, s72
    s_cselect_b32 s76, 8, 0
    s_add_u32 s73, s73, s76
    s_add_u32 s76, s73, s71
    s_mul_i32 s76, s76, 128
    s_add_u32 s35, s75, s76
    v_mfma_f32_32x32x16_bf16 v[132:147], v[30:33], v[46:49], v[132:147]
    v_mfma_f32_32x32x16_bf16 v[148:163], v[34:37], v[38:41], v[148:163]
    v_mfma_f32_32x32x16_bf16 v[164:179], v[34:37], v[42:45], v[164:179]
    v_mfma_f32_32x32x16_bf16 v[180:195], v[34:37], v[46:49], v[180:195]
    ds_read_b64_tr_b16 v[30:31], v204 offset:4096
    ds_read_b64_tr_b16 v[32:33], v204 offset:5120
    ds_read_b64_tr_b16 v[34:35], v205 offset:4096
    ds_read_b64_tr_b16 v[36:37], v205 offset:5120
    ds_read_b128 v[38:41], v207 offset:0
    ds_read_b128 v[42:45], v207 offset:4096
    ds_read_b128 v[46:49], v207 offset:8192
    s_waitcnt lgkmcnt(7)
    v_mfma_f32_32x32x16_bf16 v[100:115], v[10:13], v[18:21], v[100:115]
    v_mfma_f32_32x32x16_bf16 v[116:131], v[10:13], v[22:25], v[116:131]
    v_mfma_f32_32x32x16_bf16 v[132:147], v[10:13], v[26:29], v[132:147]
    v_mfma_f32_32x32x16_bf16 v[148:163], v[14:17], v[18:21], v[148:163]
    v_mfma_f32_32x32x16_bf16 v[164:179], v[14:17], v[22:25], v[164:179]
    v_mfma_f32_32x32x16_bf16 v[180:195], v[14:17], v[26:29], v[180:195]
    s_waitcnt vmcnt(0) lgkmcnt(0)
    s_barrier
    ds_read_b64_tr_b16 v[10:11], v204 offset:16384
    ds_read_b64_tr_b16 v[12:13], v204 offset:17408
    ds_read_b64_tr_b16 v[14:15], v205 offset:16384
    ds_read_b64_tr_b16 v[16:17], v205 offset:17408
    ds_read_b128 v[18:21], v206 offset:12288
    ds_read_b128 v[22:25], v206 offset:16384
    ds_read_b128 v[26:29], v206 offset:20480
    s_waitcnt lgkmcnt(7)
    v_mfma_f32_32x32x16_bf16 v[100:115], v[30:33], v[38:41], v[100:115]
    v_mfma_f32_32x32x16_bf16 v[116:131], v[30:33], v[42:45], v[116:131]
    v_mfma_f32_32x32x16_bf16 v[132:147], v[30:33], v[46:49], v[132:147]
    v_mfma_f32_32x32x16_bf16 v[148:163], v[34:37], v[38:41], v[148:163]
    v_mfma_f32_32x32x16_bf16 v[164:179], v[34:37], v[42:45], v[164:179]
    v_mfma_f32_32x32x16_bf16 v[180:195], v[34:37], v[46:49], v[180:195]
    ds_read_b64_tr_b16 v[30:31], v204 offset:20480
    ds_read_b64_tr_b16 v[32:33], v204 offset:21504
    ds_read_b64_tr_b16 v[34:35], v205 offset:20480
    ds_read_b64_tr_b16 v[36:37], v205 offset:21504
    ds_read_b128 v[38:41], v207 offset:12288
    ds_read_b128 v[42:45], v207 offset:16384
    ds_read_b128 v[46:49], v207 offset:20480
    s_waitcnt lgkmcnt(7)
    v_mfma_f32_32x32x16_bf16 v[100:115], v[10:13], v[18:21], v[100:115]
    v_mfma_f32_32x32x16_bf16 v[116:131], v[10:13], v[22:25], v[116:131]
    v_mfma_f32_32x32x16_bf16 v[132:147], v[10:13], v[26:29], v[132:147]
    v_mfma_f32_32x32x16_bf16 v[148:163], v[14:17], v[18:21], v[148:163]
    v_mfma_f32_32x32x16_bf16 v[164:179], v[14:17], v[22:25], v[164:179]
    v_mfma_f32_32x32x16_bf16 v[180:195], v[14:17], v[26:29], v[180:195]
    s_waitcnt lgkmcnt(0)
    v_mfma_f32_32x32x16_bf16 v[100:115], v[30:33], v[38:41], v[100:115]
    v_mfma_f32_32x32x16_bf16 v[116:131], v[30:33], v[42:45], v[116:131]
    v_mfma_f32_32x32x16_bf16 v[132:147], v[30:33], v[46:49], v[132:147]
    v_mfma_f32_32x32x16_bf16 v[148:163], v[34:37], v[38:41], v[148:163]
    v_mfma_f32_32x32x16_bf16 v[164:179], v[34:37], v[42:45], v[164:179]
    v_mfma_f32_32x32x16_bf16 v[180:195], v[34:37], v[46:49], v[180:195]
    s_nop 15
    s_barrier
    v_lshlrev_b32 v3, 4, v2
    s_mul_i32 s41, s15, 12288
    v_add_u32 v3, s41, v3
    s_xor_b32 s42, s15, 1
    s_mul_i32 s42, s42, 12288
    v_lshlrev_b32 v4, 4, v2
    v_add_u32 v4, s42, v4
    s_cmp_eq_u32 s39, 0
    s_cbranch_scc0 L_g1_e1
    ds_write_b128 v3, v[148:151] offset:0
    ds_write_b128 v3, v[152:155] offset:1024
    ds_write_b128 v3, v[156:159] offset:2048
    ds_write_b128 v3, v[160:163] offset:3072
    ds_write_b128 v3, v[164:167] offset:4096
    ds_write_b128 v3, v[168:171] offset:5120
    ds_write_b128 v3, v[172:175] offset:6144
    ds_write_b128 v3, v[176:179] offset:7168
    ds_write_b128 v3, v[180:183] offset:8192
    ds_write_b128 v3, v[184:187] offset:9216
    ds_write_b128 v3, v[188:191] offset:10240
    ds_write_b128 v3, v[192:195] offset:11264
    s_branch L_g1_e2
L_g1_e1:
    ds_write_b128 v3, v[100:103] offset:0
    ds_write_b128 v3, v[104:107] offset:1024
    ds_write_b128 v3, v[108:111] offset:2048
    ds_write_b128 v3, v[112:115] offset:3072
    ds_write_b128 v3, v[116:119] offset:4096
    ds_write_b128 v3, v[120:123] offset:5120
    ds_write_b128 v3, v[124:127] offset:6144
    ds_write_b128 v3, v[128:131] offset:7168
    ds_write_b128 v3, v[132:135] offset:8192
    ds_write_b128 v3, v[136:139] offset:9216
    ds_write_b128 v3, v[140:143] offset:10240
    ds_write_b128 v3, v[144:147] offset:11264
    s_waitcnt lgkmcnt(0)
    v_mov_b32 v100, v148
    v_mov_b32 v101, v149
    v_mov_b32 v102, v150
    v_mov_b32 v103, v151
    v_mov_b32 v104, v152
    v_mov_b32 v105, v153
    v_mov_b32 v106, v154
    v_mov_b32 v107, v155
    v_mov_b32 v108, v156
    v_mov_b32 v109, v157
    v_mov_b32 v110, v158
    v_mov_b32 v111, v159
    v_mov_b32 v112, v160
    v_mov_b32 v113, v161
    v_mov_b32 v114, v162
    v_mov_b32 v115, v163
    v_mov_b32 v116, v164
    v_mov_b32 v117, v165
    v_mov_b32 v118, v166
    v_mov_b32 v119, v167
    v_mov_b32 v120, v168
    v_mov_b32 v121, v169
    v_mov_b32 v122, v170
    v_mov_b32 v123, v171
    v_mov_b32 v124, v172
    v_mov_b32 v125, v173
    v_mov_b32 v126, v174
    v_mov_b32 v127, v175
    v_mov_b32 v128, v176
    v_mov_b32 v129, v177
    v_mov_b32 v130, v178
    v_mov_b32 v131, v179
    v_mov_b32 v132, v180
    v_mov_b32 v133, v181
    v_mov_b32 v134, v182
    v_mov_b32 v135, v183
    v_mov_b32 v136, v184
    v_mov_b32 v137, v185
    v_mov_b32 v138, v186
    v_mov_b32 v139, v187
    v_mov_b32 v140, v188
    v_mov_b32 v141, v189
    v_mov_b32 v142, v190
    v_mov_b32 v143, v191
    v_mov_b32 v144, v192
    v_mov_b32 v145, v193
    v_mov_b32 v146, v194
    v_mov_b32 v147, v195
L_g1_e2:
    s_waitcnt lgkmcnt(0)
    s_barrier
    ds_read_b128 v[148:151], v4 offset:0
    ds_read_b128 v[152:155], v4 offset:1024
    ds_read_b128 v[156:159], v4 offset:2048
    ds_read_b128 v[160:163], v4 offset:3072
    ds_read_b128 v[164:167], v4 offset:4096
    ds_read_b128 v[168:171], v4 offset:5120
    ds_read_b128 v[172:175], v4 offset:6144
    ds_read_b128 v[176:179], v4 offset:7168
    ds_read_b128 v[180:183], v4 offset:8192
    ds_read_b128 v[184:187], v4 offset:9216
    ds_read_b128 v[188:191], v4 offset:10240
    ds_read_b128 v[192:195], v4 offset:11264
    v_and_b32 v8, 31, v2
    s_mul_i32 s41, s14, 96
    v_add_u32 v8, s41, v8
    v_mul_u32_u24 v8, 9216, v8
    v_add_u32 v8, v8, v222
    s_mov_b32 s44, 0x3dd2d3e8
    s_mov_b32 s45, 0x40135761
    v_mov_b32 v9, s45
    s_waitcnt vmcnt(0) lgkmcnt(0)
    v_lshlrev_b32 v10, 16, v212
    v_and_b32 v11, 0xffff0000, v212
    v_lshlrev_b32 v12, 16, v213
    v_and_b32 v13, 0xffff0000, v213
    v_lshlrev_b32 v14, 16, v214
    v_and_b32 v15, 0xffff0000, v214
    v_lshlrev_b32 v16, 16, v215
    v_and_b32 v17, 0xffff0000, v215
    v_lshlrev_b32 v18, 16, v216
    v_and_b32 v19, 0xffff0000, v216
    v_lshlrev_b32 v20, 16, v217
    v_and_b32 v21, 0xffff0000, v217
    v_lshlrev_b32 v22, 16, v218
    v_and_b32 v23, 0xffff0000, v218
    v_lshlrev_b32 v24, 16, v219
    v_and_b32 v25, 0xffff0000, v219
    v_add_f32 v100, v100, v148
    v_add_f32 v101, v101, v149
    v_add_f32 v102, v102, v150
    v_add_f32 v103, v103, v151
    v_cvt_pk_bf16_f32 v30, v100, v101
    v_lshlrev_b32 v100, 16, v30
    v_and_b32 v101, 0xffff0000, v30
    v_cvt_pk_bf16_f32 v31, v102, v103
    v_lshlrev_b32 v102, 16, v31
    v_and_b32 v103, 0xffff0000, v31
    v_add_f32 v100, v100, v10
    v_add_f32 v101, v101, v11
    v_add_f32 v102, v102, v12
    v_add_f32 v103, v103, v13
    v_cvt_pk_bf16_f32 v30, v100, v101
    v_lshlrev_b32 v100, 16, v30
    v_and_b32 v101, 0xffff0000, v30
    v_cvt_pk_bf16_f32 v31, v102, v103
    v_lshlrev_b32 v102, 16, v31
    v_and_b32 v103, 0xffff0000, v31
    v_mul_f32 v32, v100, v100
    v_mul_f32 v33, v101, v101
    v_mul_f32 v34, v102, v102
    v_mul_f32 v35, v103, v103
    v_fma_f32 v32, v32, s44, v9
    v_fma_f32 v33, v33, s44, v9
    v_fma_f32 v34, v34, s44, v9
    v_fma_f32 v35, v35, s44, v9
    v_mul_f32 v32, v32, v100
    v_mul_f32 v33, v33, v101
    v_mul_f32 v34, v34, v102
    v_mul_f32 v35, v35, v103
    v_exp_f32 v32, v32
    v_exp_f32 v33, v33
    v_exp_f32 v34, v34
    v_exp_f32 v35, v35
    v_add_f32 v32, 1.0, v32
    v_add_f32 v33, 1.0, v33
    v_add_f32 v34, 1.0, v34
    v_add_f32 v35, 1.0, v35
    v_rcp_f32 v32, v32
    v_rcp_f32 v33, v33
    v_rcp_f32 v34, v34
    v_rcp_f32 v35, v35
    s_nop 0
    v_fma_f32 v100, -v100, v32, v100
    v_fma_f32 v101, -v101, v33, v101
    v_fma_f32 v102, -v102, v34, v102
    v_fma_f32 v103, -v103, v35, v103
    v_cvt_pk_bf16_f32 v36, v100, v101
    v_cvt_pk_bf16_f32 v37, v102, v103
    s_mov_b32 s46, 0
    buffer_store_dwordx2 v[36:37], v8, s[28:31], s46 offen offset:0
    v_add_f32 v104, v104, v152
    v_add_f32 v105, v105, v153
    v_add_f32 v106, v106, v154
    v_add_f32 v107, v107, v155
    v_cvt_pk_bf16_f32 v30, v104, v105
    v_lshlrev_b32 v104, 16, v30
    v_and_b32 v105, 0xffff0000, v30
    v_cvt_pk_bf16_f32 v31, v106, v107
    v_lshlrev_b32 v106, 16, v31
    v_and_b32 v107, 0xffff0000, v31
    v_add_f32 v104, v104, v14
    v_add_f32 v105, v105, v15
    v_add_f32 v106, v106, v16
    v_add_f32 v107, v107, v17
    v_cvt_pk_bf16_f32 v30, v104, v105
    v_lshlrev_b32 v104, 16, v30
    v_and_b32 v105, 0xffff0000, v30
    v_cvt_pk_bf16_f32 v31, v106, v107
    v_lshlrev_b32 v106, 16, v31
    v_and_b32 v107, 0xffff0000, v31
    v_mul_f32 v32, v104, v104
    v_mul_f32 v33, v105, v105
    v_mul_f32 v34, v106, v106
    v_mul_f32 v35, v107, v107
    v_fma_f32 v32, v32, s44, v9
    v_fma_f32 v33, v33, s44, v9
    v_fma_f32 v34, v34, s44, v9
    v_fma_f32 v35, v35, s44, v9
    v_mul_f32 v32, v32, v104
    v_mul_f32 v33, v33, v105
    v_mul_f32 v34, v34, v106
    v_mul_f32 v35, v35, v107
    v_exp_f32 v32, v32
    v_exp_f32 v33, v33
    v_exp_f32 v34, v34
    v_exp_f32 v35, v35
    v_add_f32 v32, 1.0, v32
    v_add_f32 v33, 1.0, v33
    v_add_f32 v34, 1.0, v34
    v_add_f32 v35, 1.0, v35
    v_rcp_f32 v32, v32
    v_rcp_f32 v33, v33
    v_rcp_f32 v34, v34
    v_rcp_f32 v35, v35
    s_nop 0
    v_fma_f32 v104, -v104, v32, v104
    v_fma_f32 v105, -v105, v33, v105
    v_fma_f32 v106, -v106, v34, v106
    v_fma_f32 v107, -v107, v35, v107
    v_cvt_pk_bf16_f32 v36, v104, v105
    v_cvt_pk_bf16_f32 v37, v106, v107
    s_mov_b32 s46, 0
    buffer_store_dwordx2 v[36:37], v8, s[28:31], s46 offen offset:16
    v_add_f32 v108, v108, v156
    v_add_f32 v109, v109, v157
    v_add_f32 v110, v110, v158
    v_add_f32 v111, v111, v159
    v_cvt_pk_bf16_f32 v30, v108, v109
    v_lshlrev_b32 v108, 16, v30
    v_and_b32 v109, 0xffff0000, v30
    v_cvt_pk_bf16_f32 v31, v110, v111
    v_lshlrev_b32 v110, 16, v31
    v_and_b32 v111, 0xffff0000, v31
    v_add_f32 v108, v108, v18
    v_add_f32 v109, v109, v19
    v_add_f32 v110, v110, v20
    v_add_f32 v111, v111, v21
    v_cvt_pk_bf16_f32 v30, v108, v109
    v_lshlrev_b32 v108, 16, v30
    v_and_b32 v109, 0xffff0000, v30
    v_cvt_pk_bf16_f32 v31, v110, v111
    v_lshlrev_b32 v110, 16, v31
    v_and_b32 v111, 0xffff0000, v31
    v_mul_f32 v32, v108, v108
    v_mul_f32 v33, v109, v109
    v_mul_f32 v34, v110, v110
    v_mul_f32 v35, v111, v111
    v_fma_f32 v32, v32, s44, v9
    v_fma_f32 v33, v33, s44, v9
    v_fma_f32 v34, v34, s44, v9
    v_fma_f32 v35, v35, s44, v9
    v_mul_f32 v32, v32, v108
    v_mul_f32 v33, v33, v109
    v_mul_f32 v34, v34, v110
    v_mul_f32 v35, v35, v111
    v_exp_f32 v32, v32
    v_exp_f32 v33, v33
    v_exp_f32 v34, v34
    v_exp_f32 v35, v35
    v_add_f32 v32, 1.0, v32
    v_add_f32 v33, 1.0, v33
    v_add_f32 v34, 1.0, v34
    v_add_f32 v35, 1.0, v35
    v_rcp_f32 v32, v32
    v_rcp_f32 v33, v33
    v_rcp_f32 v34, v34
    v_rcp_f32 v35, v35
    s_nop 0
    v_fma_f32 v108, -v108, v32, v108
    v_fma_f32 v109, -v109, v33, v109
    v_fma_f32 v110, -v110, v34, v110
    v_fma_f32 v111, -v111, v35, v111
    v_cvt_pk_bf16_f32 v36, v108, v109
    v_cvt_pk_bf16_f32 v37, v110, v111
    s_mov_b32 s46, 0
    buffer_store_dwordx2 v[36:37], v8, s[28:31], s46 offen offset:32
    v_add_f32 v112, v112, v160
    v_add_f32 v113, v113, v161
    v_add_f32 v114, v114, v162
    v_add_f32 v115, v115, v163
    v_cvt_pk_bf16_f32 v30, v112, v113
    v_lshlrev_b32 v112, 16, v30
    v_and_b32 v113, 0xffff0000, v30
    v_cvt_pk_bf16_f32 v31, v114, v115
    v_lshlrev_b32 v114, 16, v31
    v_and_b32 v115, 0xffff0000, v31
    v_add_f32 v112, v112, v22
    v_add_f32 v113, v113, v23
    v_add_f32 v114, v114, v24
    v_add_f32 v115, v115, v25
    v_cvt_pk_bf16_f32 v30, v112, v113
    v_lshlrev_b32 v112, 16, v30
    v_and_b32 v113, 0xffff0000, v30
    v_cvt_pk_bf16_f32 v31, v114, v115
    v_lshlrev_b32 v114, 16, v31
    v_and_b32 v115, 0xffff0000, v31
    v_mul_f32 v32, v112, v112
    v_mul_f32 v33, v113, v113
    v_mul_f32 v34, v114, v114
    v_mul_f32 v35, v115, v115
    v_fma_f32 v32, v32, s44, v9
    v_fma_f32 v33, v33, s44, v9
    v_fma_f32 v34, v34, s44, v9
    v_fma_f32 v35, v35, s44, v9
    v_mul_f32 v32, v32, v112
    v_mul_f32 v33, v33, v113
    v_mul_f32 v34, v34, v114
    v_mul_f32 v35, v35, v115
    v_exp_f32 v32, v32
    v_exp_f32 v33, v33
    v_exp_f32 v34, v34
    v_exp_f32 v35, v35
    v_add_f32 v32, 1.0, v32
    v_add_f32 v33, 1.0, v33
    v_add_f32 v34, 1.0, v34
    v_add_f32 v35, 1.0, v35
    v_rcp_f32 v32, v32
    v_rcp_f32 v33, v33
    v_rcp_f32 v34, v34
    v_rcp_f32 v35, v35
    s_nop 0
    v_fma_f32 v112, -v112, v32, v112
    v_fma_f32 v113, -v113, v33, v113
    v_fma_f32 v114, -v114, v34, v114
    v_fma_f32 v115, -v115, v35, v115
    v_cvt_pk_bf16_f32 v36, v112, v113
    v_cvt_pk_bf16_f32 v37, v114, v115
    s_mov_b32 s46, 0
    buffer_store_dwordx2 v[36:37], v8, s[28:31], s46 offen offset:48
    v_add_f32 v116, v116, v164
    v_add_f32 v117, v117, v165
    v_add_f32 v118, v118, v166
    v_add_f32 v119, v119, v167
    v_cvt_pk_bf16_f32 v30, v116, v117
    v_lshlrev_b32 v116, 16, v30
    v_and_b32 v117, 0xffff0000, v30
    v_cvt_pk_bf16_f32 v31, v118, v119
    v_lshlrev_b32 v118, 16, v31
    v_and_b32 v119, 0xffff0000, v31
    v_add_f32 v116, v116, v10
    v_add_f32 v117, v117, v11
    v_add_f32 v118, v118, v12
    v_add_f32 v119, v119, v13
    v_cvt_pk_bf16_f32 v30, v116, v117
    v_lshlrev_b32 v116, 16, v30
    v_and_b32 v117, 0xffff0000, v30
    v_cvt_pk_bf16_f32 v31, v118, v119
    v_lshlrev_b32 v118, 16, v31
    v_and_b32 v119, 0xffff0000, v31
    v_mul_f32 v32, v116, v116
    v_mul_f32 v33, v117, v117
    v_mul_f32 v34, v118, v118
    v_mul_f32 v35, v119, v119
    v_fma_f32 v32, v32, s44, v9
    v_fma_f32 v33, v33, s44, v9
    v_fma_f32 v34, v34, s44, v9
    v_fma_f32 v35, v35, s44, v9
    v_mul_f32 v32, v32, v116
    v_mul_f32 v33, v33, v117
    v_mul_f32 v34, v34, v118
    v_mul_f32 v35, v35, v119
    v_exp_f32 v32, v32
    v_exp_f32 v33, v33
    v_exp_f32 v34, v34
    v_exp_f32 v35, v35
    v_add_f32 v32, 1.0, v32
    v_add_f32 v33, 1.0, v33
    v_add_f32 v34, 1.0, v34
    v_add_f32 v35, 1.0, v35
    v_rcp_f32 v32, v32
    v_rcp_f32 v33, v33
    v_rcp_f32 v34, v34
    v_rcp_f32 v35, v35
    s_nop 0
    v_fma_f32 v116, -v116, v32, v116
    v_fma_f32 v117, -v117, v33, v117
    v_fma_f32 v118, -v118, v34, v118
    v_fma_f32 v119, -v119, v35, v119
    v_cvt_pk_bf16_f32 v36, v116, v117
    v_cvt_pk_bf16_f32 v37, v118, v119
    s_mov_b32 s46, 294912
    buffer_store_dwordx2 v[36:37], v8, s[28:31], s46 offen offset:0
    v_add_f32 v120, v120, v168
    v_add_f32 v121, v121, v169
    v_add_f32 v122, v122, v170
    v_add_f32 v123, v123, v171
    v_cvt_pk_bf16_f32 v30, v120, v121
    v_lshlrev_b32 v120, 16, v30
    v_and_b32 v121, 0xffff0000, v30
    v_cvt_pk_bf16_f32 v31, v122, v123
    v_lshlrev_b32 v122, 16, v31
    v_and_b32 v123, 0xffff0000, v31
    v_add_f32 v120, v120, v14
    v_add_f32 v121, v121, v15
    v_add_f32 v122, v122, v16
    v_add_f32 v123, v123, v17
    v_cvt_pk_bf16_f32 v30, v120, v121
    v_lshlrev_b32 v120, 16, v30
    v_and_b32 v121, 0xffff0000, v30
    v_cvt_pk_bf16_f32 v31, v122, v123
    v_lshlrev_b32 v122, 16, v31
    v_and_b32 v123, 0xffff0000, v31
    v_mul_f32 v32, v120, v120
    v_mul_f32 v33, v121, v121
    v_mul_f32 v34, v122, v122
    v_mul_f32 v35, v123, v123
    v_fma_f32 v32, v32, s44, v9
    v_fma_f32 v33, v33, s44, v9
    v_fma_f32 v34, v34, s44, v9
    v_fma_f32 v35, v35, s44, v9
    v_mul_f32 v32, v32, v120
    v_mul_f32 v33, v33, v121
    v_mul_f32 v34, v34, v122
    v_mul_f32 v35, v35, v123
    v_exp_f32 v32, v32
    v_exp_f32 v33, v33
    v_exp_f32 v34, v34
    v_exp_f32 v35, v35
    v_add_f32 v32, 1.0, v32
    v_add_f32 v33, 1.0, v33
    v_add_f32 v34, 1.0, v34
    v_add_f32 v35, 1.0, v35
    v_rcp_f32 v32, v32
    v_rcp_f32 v33, v33
    v_rcp_f32 v34, v34
    v_rcp_f32 v35, v35
    s_nop 0
    v_fma_f32 v120, -v120, v32, v120
    v_fma_f32 v121, -v121, v33, v121
    v_fma_f32 v122, -v122, v34, v122
    v_fma_f32 v123, -v123, v35, v123
    v_cvt_pk_bf16_f32 v36, v120, v121
    v_cvt_pk_bf16_f32 v37, v122, v123
    s_mov_b32 s46, 294912
    buffer_store_dwordx2 v[36:37], v8, s[28:31], s46 offen offset:16
    v_add_f32 v124, v124, v172
    v_add_f32 v125, v125, v173
    v_add_f32 v126, v126, v174
    v_add_f32 v127, v127, v175
    v_cvt_pk_bf16_f32 v30, v124, v125
    v_lshlrev_b32 v124, 16, v30
    v_and_b32 v125, 0xffff0000, v30
    v_cvt_pk_bf16_f32 v31, v126, v127
    v_lshlrev_b32 v126, 16, v31
    v_and_b32 v127, 0xffff0000, v31
    v_add_f32 v124, v124, v18
    v_add_f32 v125, v125, v19
    v_add_f32 v126, v126, v20
    v_add_f32 v127, v127, v21
    v_cvt_pk_bf16_f32 v30, v124, v125
    v_lshlrev_b32 v124, 16, v30
    v_and_b32 v125, 0xffff0000, v30
    v_cvt_pk_bf16_f32 v31, v126, v127
    v_lshlrev_b32 v126, 16, v31
    v_and_b32 v127, 0xffff0000, v31
    v_mul_f32 v32, v124, v124
    v_mul_f32 v33, v125, v125
    v_mul_f32 v34, v126, v126
    v_mul_f32 v35, v127, v127
    v_fma_f32 v32, v32, s44, v9
    v_fma_f32 v33, v33, s44, v9
    v_fma_f32 v34, v34, s44, v9
    v_fma_f32 v35, v35, s44, v9
    v_mul_f32 v32, v32, v124
    v_mul_f32 v33, v33, v125
    v_mul_f32 v34, v34, v126
    v_mul_f32 v35, v35, v127
    v_exp_f32 v32, v32
    v_exp_f32 v33, v33
    v_exp_f32 v34, v34
    v_exp_f32 v35, v35
    v_add_f32 v32, 1.0, v32
    v_add_f32 v33, 1.0, v33
    v_add_f32 v34, 1.0, v34
    v_add_f32 v35, 1.0, v35
    v_rcp_f32 v32, v32
    v_rcp_f32 v33, v33
    v_rcp_f32 v34, v34
    v_rcp_f32 v35, v35
    s_nop 0
    v_fma_f32 v124, -v124, v32, v124
    v_fma_f32 v125, -v125, v33, v125
    v_fma_f32 v126, -v126, v34, v126
    v_fma_f32 v127, -v127, v35, v127
    v_cvt_pk_bf16_f32 v36, v124, v125
    v_cvt_pk_bf16_f32 v37, v126, v127
    s_mov_b32 s46, 294912
    buffer_store_dwordx2 v[36:37], v8, s[28:31], s46 offen offset:32
    v_add_f32 v128, v128, v176
    v_add_f32 v129, v129, v177
    v_add_f32 v130, v130, v178
    v_add_f32 v131, v131, v179
    v_cvt_pk_bf16_f32 v30, v128, v129
    v_lshlrev_b32 v128, 16, v30
    v_and_b32 v129, 0xffff0000, v30
    v_cvt_pk_bf16_f32 v31, v130, v131
    v_lshlrev_b32 v130, 16, v31
    v_and_b32 v131, 0xffff0000, v31
    v_add_f32 v128, v128, v22
    v_add_f32 v129, v129, v23
    v_add_f32 v130, v130, v24
    v_add_f32 v131, v131, v25
    v_cvt_pk_bf16_f32 v30, v128, v129
    v_lshlrev_b32 v128, 16, v30
    v_and_b32 v129, 0xffff0000, v30
    v_cvt_pk_bf16_f32 v31, v130, v131
    v_lshlrev_b32 v130, 16, v31
    v_and_b32 v131, 0xffff0000, v31
    v_mul_f32 v32, v128, v128
    v_mul_f32 v33, v129, v129
    v_mul_f32 v34, v130, v130
    v_mul_f32 v35, v131, v131
    v_fma_f32 v32, v32, s44, v9
    v_fma_f32 v33, v33, s44, v9
    v_fma_f32 v34, v34, s44, v9
    v_fma_f32 v35, v35, s44, v9
    v_mul_f32 v32, v32, v128
    v_mul_f32 v33, v33, v129
    v_mul_f32 v34, v34, v130
    v_mul_f32 v35, v35, v131
    v_exp_f32 v32, v32
    v_exp_f32 v33, v33
    v_exp_f32 v34, v34
    v_exp_f32 v35, v35
    v_add_f32 v32, 1.0, v32
    v_add_f32 v33, 1.0, v33
    v_add_f32 v34, 1.0, v34
    v_add_f32 v35, 1.0, v35
    v_rcp_f32 v32, v32
    v_rcp_f32 v33, v33
    v_rcp_f32 v34, v34
    v_rcp_f32 v35, v35
    s_nop 0
    v_fma_f32 v128, -v128, v32, v128
    v_fma_f32 v129, -v129, v33, v129
    v_fma_f32 v130, -v130, v34, v130
    v_fma_f32 v131, -v131, v35, v131
    v_cvt_pk_bf16_f32 v36, v128, v129
    v_cvt_pk_bf16_f32 v37, v130, v131
    s_mov_b32 s46, 294912
    buffer_store_dwordx2 v[36:37], v8, s[28:31], s46 offen offset:48
    v_add_f32 v132, v132, v180
    v_add_f32 v133, v133, v181
    v_add_f32 v134, v134, v182
    v_add_f32 v135, v135, v183
    v_cvt_pk_bf16_f32 v30, v132, v133
    v_lshlrev_b32 v132, 16, v30
    v_and_b32 v133, 0xffff0000, v30
    v_cvt_pk_bf16_f32 v31, v134, v135
    v_lshlrev_b32 v134, 16, v31
    v_and_b32 v135, 0xffff0000, v31
    v_add_f32 v132, v132, v10
    v_add_f32 v133, v133, v11
    v_add_f32 v134, v134, v12
    v_add_f32 v135, v135, v13
    v_cvt_pk_bf16_f32 v30, v132, v133
    v_lshlrev_b32 v132, 16, v30
    v_and_b32 v133, 0xffff0000, v30
    v_cvt_pk_bf16_f32 v31, v134, v135
    v_lshlrev_b32 v134, 16, v31
    v_and_b32 v135, 0xffff0000, v31
    v_mul_f32 v32, v132, v132
    v_mul_f32 v33, v133, v133
    v_mul_f32 v34, v134, v134
    v_mul_f32 v35, v135, v135
    v_fma_f32 v32, v32, s44, v9
    v_fma_f32 v33, v33, s44, v9
    v_fma_f32 v34, v34, s44, v9
    v_fma_f32 v35, v35, s44, v9
    v_mul_f32 v32, v32, v132
    v_mul_f32 v33, v33, v133
    v_mul_f32 v34, v34, v134
    v_mul_f32 v35, v35, v135
    v_exp_f32 v32, v32
    v_exp_f32 v33, v33
    v_exp_f32 v34, v34
    v_exp_f32 v35, v35
    v_add_f32 v32, 1.0, v32
    v_add_f32 v33, 1.0, v33
    v_add_f32 v34, 1.0, v34
    v_add_f32 v35, 1.0, v35
    v_rcp_f32 v32, v32
    v_rcp_f32 v33, v33
    v_rcp_f32 v34, v34
    v_rcp_f32 v35, v35
    s_nop 0
    v_fma_f32 v132, -v132, v32, v132
    v_fma_f32 v133, -v133, v33, v133
    v_fma_f32 v134, -v134, v34, v134
    v_fma_f32 v135, -v135, v35, v135
    v_cvt_pk_bf16_f32 v36, v132, v133
    v_cvt_pk_bf16_f32 v37, v134, v135
    s_mov_b32 s46, 589824
    buffer_store_dwordx2 v[36:37], v8, s[28:31], s46 offen offset:0
    v_add_f32 v136, v136, v184
    v_add_f32 v137, v137, v185
    v_add_f32 v138, v138, v186
    v_add_f32 v139, v139, v187
    v_cvt_pk_bf16_f32 v30, v136, v137
    v_lshlrev_b32 v136, 16, v30
    v_and_b32 v137, 0xffff0000, v30
    v_cvt_pk_bf16_f32 v31, v138, v139
    v_lshlrev_b32 v138, 16, v31
    v_and_b32 v139, 0xffff0000, v31
    v_add_f32 v136, v136, v14
    v_add_f32 v137, v137, v15
    v_add_f32 v138, v138, v16
    v_add_f32 v139, v139, v17
    v_cvt_pk_bf16_f32 v30, v136, v137
    v_lshlrev_b32 v136, 16, v30
    v_and_b32 v137, 0xffff0000, v30
    v_cvt_pk_bf16_f32 v31, v138, v139
    v_lshlrev_b32 v138, 16, v31
    v_and_b32 v139, 0xffff0000, v31
    v_mul_f32 v32, v136, v136
    v_mul_f32 v33, v137, v137
    v_mul_f32 v34, v138, v138
    v_mul_f32 v35, v139, v139
    v_fma_f32 v32, v32, s44, v9
    v_fma_f32 v33, v33, s44, v9
    v_fma_f32 v34, v34, s44, v9
    v_fma_f32 v35, v35, s44, v9
    v_mul_f32 v32, v32, v136
    v_mul_f32 v33, v33, v137
    v_mul_f32 v34, v34, v138
    v_mul_f32 v35, v35, v139
    v_exp_f32 v32, v32
    v_exp_f32 v33, v33
    v_exp_f32 v34, v34
    v_exp_f32 v35, v35
    v_add_f32 v32, 1.0, v32
    v_add_f32 v33, 1.0, v33
    v_add_f32 v34, 1.0, v34
    v_add_f32 v35, 1.0, v35
    v_rcp_f32 v32, v32
    v_rcp_f32 v33, v33
    v_rcp_f32 v34, v34
    v_rcp_f32 v35, v35
    s_nop 0
    v_fma_f32 v136, -v136, v32, v136
    v_fma_f32 v137, -v137, v33, v137
    v_fma_f32 v138, -v138, v34, v138
    v_fma_f32 v139, -v139, v35, v139
    v_cvt_pk_bf16_f32 v36, v136, v137
    v_cvt_pk_bf16_f32 v37, v138, v139
    s_mov_b32 s46, 589824
    buffer_store_dwordx2 v[36:37], v8, s[28:31], s46 offen offset:16
    v_add_f32 v140, v140, v188
    v_add_f32 v141, v141, v189
    v_add_f32 v142, v142, v190
    v_add_f32 v143, v143, v191
    v_cvt_pk_bf16_f32 v30, v140, v141
    v_lshlrev_b32 v140, 16, v30
    v_and_b32 v141, 0xffff0000, v30
    v_cvt_pk_bf16_f32 v31, v142, v143
    v_lshlrev_b32 v142, 16, v31
    v_and_b32 v143, 0xffff0000, v31
    v_add_f32 v140, v140, v18
    v_add_f32 v141, v141, v19
    v_add_f32 v142, v142, v20
    v_add_f32 v143, v143, v21
    v_cvt_pk_bf16_f32 v30, v140, v141
    v_lshlrev_b32 v140, 16, v30
    v_and_b32 v141, 0xffff0000, v30
    v_cvt_pk_bf16_f32 v31, v142, v143
    v_lshlrev_b32 v142, 16, v31
    v_and_b32 v143, 0xffff0000, v31
    v_mul_f32 v32, v140, v140
    v_mul_f32 v33, v141, v141
    v_mul_f32 v34, v142, v142
    v_mul_f32 v35, v143, v143
    v_fma_f32 v32, v32, s44, v9
    v_fma_f32 v33, v33, s44, v9
    v_fma_f32 v34, v34, s44, v9
    v_fma_f32 v35, v35, s44, v9
    v_mul_f32 v32, v32, v140
    v_mul_f32 v33, v33, v141
    v_mul_f32 v34, v34, v142
    v_mul_f32 v35, v35, v143
    v_exp_f32 v32, v32
    v_exp_f32 v33, v33
    v_exp_f32 v34, v34
    v_exp_f32 v35, v35
    v_add_f32 v32, 1.0, v32
    v_add_f32 v33, 1.0, v33
    v_add_f32 v34, 1.0, v34
    v_add_f32 v35, 1.0, v35
    v_rcp_f32 v32, v32
    v_rcp_f32 v33, v33
    v_rcp_f32 v34, v34
    v_rcp_f32 v35, v35
    s_nop 0
    v_fma_f32 v140, -v140, v32, v140
    v_fma_f32 v141, -v141, v33, v141
    v_fma_f32 v142, -v142, v34, v142
    v_fma_f32 v143, -v143, v35, v143
    v_cvt_pk_bf16_f32 v36, v140, v141
    v_cvt_pk_bf16_f32 v37, v142, v143
    s_mov_b32 s46, 589824
    buffer_store_dwordx2 v[36:37], v8, s[28:31], s46 offen offset:32
    v_add_f32 v144, v144, v192
    v_add_f32 v145, v145, v193
    v_add_f32 v146, v146, v194
    v_add_f32 v147, v147, v195
    v_cvt_pk_bf16_f32 v30, v144, v145
    v_lshlrev_b32 v144, 16, v30
    v_and_b32 v145, 0xffff0000, v30
    v_cvt_pk_bf16_f32 v31, v146, v147
    v_lshlrev_b32 v146, 16, v31
    v_and_b32 v147, 0xffff0000, v31
    v_add_f32 v144, v144, v22
    v_add_f32 v145, v145, v23
    v_add_f32 v146, v146, v24
    v_add_f32 v147, v147, v25
    v_cvt_pk_bf16_f32 v30, v144, v145
    v_lshlrev_b32 v144, 16, v30
    v_and_b32 v145, 0xffff0000, v30
    v_cvt_pk_bf16_f32 v31, v146, v147
    v_lshlrev_b32 v146, 16, v31
    v_and_b32 v147, 0xffff0000, v31
    v_mul_f32 v32, v144, v144
    v_mul_f32 v33, v145, v145
    v_mul_f32 v34, v146, v146
    v_mul_f32 v35, v147, v147
    v_fma_f32 v32, v32, s44, v9
    v_fma_f32 v33, v33, s44, v9
    v_fma_f32 v34, v34, s44, v9
    v_fma_f32 v35, v35, s44, v9
    v_mul_f32 v32, v32, v144
    v_mul_f32 v33, v33, v145
    v_mul_f32 v34, v34, v146
    v_mul_f32 v35, v35, v147
    v_exp_f32 v32, v32
    v_exp_f32 v33, v33
    v_exp_f32 v34, v34
    v_exp_f32 v35, v35
    v_add_f32 v32, 1.0, v32
    v_add_f32 v33, 1.0, v33
    v_add_f32 v34, 1.0, v34
    v_add_f32 v35, 1.0, v35
    v_rcp_f32 v32, v32
    v_rcp_f32 v33, v33
    v_rcp_f32 v34, v34
    v_rcp_f32 v35, v35
    s_nop 0
    v_fma_f32 v144, -v144, v32, v144
    v_fma_f32 v145, -v145, v33, v145
    v_fma_f32 v146, -v146, v34, v146
    v_fma_f32 v147, -v147, v35, v147
    v_cvt_pk_bf16_f32 v36, v144, v145
    v_cvt_pk_bf16_f32 v37, v146, v147
    s_mov_b32 s46, 589824
    buffer_store_dwordx2 v[36:37], v8, s[28:31], s46 offen offset:48
    s_endpgm
L_mix_ssm:
    s_sub_u32 s2, s2, 216
    s_setprio 3
    s_cmp_ge_u32 s2, 288
    s_cbranch_scc1 L_kc_done
    s_load_dwordx4 s[4:7], s[0:1], 8
    s_load_dwordx4 s[8:11], s[0:1], 24
    s_load_dwordx4 s[12:15], s[0:1], 40
    s_load_dwordx2 s[16:17], s[0:1], 120
    v_lshrrev_b32 v1, 6, v0
    v_and_b32 v2, 63, v0
    v_and_b32 v3, 15, v0
    v_bfe_u32 v4, v0, 4, 2
    s_nop 0
    v_readfirstlane_b32 s18, v1
    s_waitcnt lgkmcnt(0)
    s_mov_b32 s20, s4
    s_mov_b32 s21, s5
    s_mov_b32 s22, 0x24000
    s_mov_b32 s23, 0x00020000
    s_mov_b32 s24, s6
    s_mov_b32 s25, s7
    s_mov_b32 s26, 0x24000
    s_mov_b32 s27, 0x00020000
    s_mov_b32 s28, s8
    s_mov_b32 s29, s9
    s_mov_b32 s30, 0x24000
    s_mov_b32 s31, 0x00020000
    s_mov_b32 s32, s10
    s_mov_b32 s33, s11
    s_mov_b32 s34, 0x24000
    s_mov_b32 s35, 0x00020000
    s_mov_b32 s36, s12
    s_mov_b32 s37, s13
    s_mov_b32 s38, 0x480
    s_mov_b32 s39, 0x00020000
    s_mov_b32 s40, s14
    s_mov_b32 s41, s15
    s_mov_b32 s42, 0x480
    s_mov_b32 s43, 0x00020000
    s_lshl_b32 s19, s2, 8
    s_lshl_b32 s52, s18, 6
    s_add_u32 s19, s19, s52
    v_lshlrev_b32 v218, 4, v4
    v_add_u32 v218, s19, v218
    buffer_load_dwordx4 v[200:203], v218, s[20:23], 0 offen
    buffer_load_dwordx4 v[204:207], v218, s[24:27], 0 offen
    buffer_load_dwordx4 v[208:211], v218, s[28:31], 0 offen
    buffer_load_dwordx4 v[212:215], v218, s[32:35], 0 offen
    s_lshl_b32 s19, s2, 1
    v_mov_b32 v219, s19
    buffer_load_ushort v216, v219, s[36:39], 0 offen
    buffer_load_ushort v217, v219, s[40:43], 0 offen
    s_mov_b32 s57, 0
L_kc_loop:
    s_lshl_b32 s19, s2, 12
    s_add_u32 s44, s16, s19
    s_addc_u32 s45, s17, 0
    s_add_u32 s48, s44, 0x990000
    s_addc_u32 s49, s45, 0
    s_add_u32 s44, s44, 0x240000
    s_addc_u32 s45, s45, 0
    s_mov_b32 s46, 4096
    s_mov_b32 s47, 0x00020000
    s_mov_b32 s50, 4096
    s_mov_b32 s51, 0x00020000
    v_lshlrev_b32 v6, 4, v3
    v_lshrrev_b32 v7, 1, v4
    v_lshlrev_b32 v7, 4, v7
    v_sub_u32 v6, v6, v7
    v_and_b32 v7, 1, v4
    v_lshl_add_u32 v6, v7, 3, v6
    v_lshlrev_b32 v6, 1, v6
    s_lshl_b32 s19, s18, 6
    v_subrev_u32 v6, s19, v6
    v_mov_b32 v8, 0x7ffffff0
    v_add_u32 v7, 4294967040, v6
    v_cmp_gt_i32 vcc, 0, v7
    s_nop 1
    v_cndmask_b32 v7, v7, v8, vcc
    buffer_load_dwordx4 v[128:131], v7, s[44:47], 0 offen
    v_add_u32 v7, 0, v6
    v_cmp_gt_i32 vcc, 0, v7
    s_nop 1
    v_cndmask_b32 v7, v7, v8, vcc
    buffer_load_dwordx4 v[132:135], v7, s[44:47], 0 offen
    v_add_u32 v7, 256, v6
    v_cmp_gt_i32 vcc, 0, v7
    s_nop 1
    v_cndmask_b32 v7, v7, v8, vcc
    buffer_load_dwordx4 v[136:139], v7, s[44:47], 0 offen
    v_add_u32 v7, 512, v6
    buffer_load_dwordx4 v[140:143], v7, s[44:47], 0 offen
    v_add_u32 v7, 768, v6
    buffer_load_dwordx4 v[144:147], v7, s[44:47], 0 offen
    v_add_u32 v7, 1024, v6
    buffer_load_dwordx4 v[148:151], v7, s[44:47], 0 offen
    v_add_u32 v7, 1280, v6
    buffer_load_dwordx4 v[152:155], v7, s[44:47], 0 offen
    v_add_u32 v7, 1536, v6
    buffer_load_dwordx4 v[156:159], v7, s[44:47], 0 offen
    v_add_u32 v7, 1792, v6
    buffer_load_dwordx4 v[160:163], v7, s[44:47], 0 offen
    v_add_u32 v7, 2048, v6
    buffer_load_dwordx4 v[164:167], v7, s[44:47], 0 offen
    v_add_u32 v7, 2304, v6
    buffer_load_dwordx4 v[168:171], v7, s[44:47], 0 offen
    v_add_u32 v7, 2560, v6
    buffer_load_dwordx4 v[172:175], v7, s[44:47], 0 offen
    v_add_u32 v7, 2816, v6
    buffer_load_dwordx4 v[176:179], v7, s[44:47], 0 offen
    v_add_u32 v7, 3072, v6
    buffer_load_dwordx4 v[180:183], v7, s[44:47], 0 offen
    v_add_u32 v7, 3328, v6
    buffer_load_dwordx4 v[184:187], v7, s[44:47], 0 offen
    v_add_u32 v7, 3584, v6
    buffer_load_dwordx4 v[188:191], v7, s[44:47], 0 offen
    v_lshlrev_b32 v7, 4, v0
    buffer_load_dwordx4 v[192:195], v7, s[44:47], 0 offen
    s_waitcnt vmcnt(17)
    v_mov_b32 v10, v200
    v_mov_b32 v11, v201
    v_mov_b32 v12, v202
    v_mov_b32 v13, v203
    v_mov_b32 v14, v204
    v_mov_b32 v15, v205
    v_mov_b32 v16, v206
    v_mov_b32 v17, v207
    v_mov_b32 v18, v208
    v_mov_b32 v19, v209
    v_mov_b32 v20, v210
    v_mov_b32 v21, v211
    v_mov_b32 v22, v212
    v_mov_b32 v23, v213
    v_mov_b32 v24, v214
    v_mov_b32 v25, v215
    v_mov_b32 v26, v216
    v_mov_b32 v27, v217
    v_lshlrev_b32 v26, 16, v26
    v_lshlrev_b32 v27, 16, v27
    v_mul_f32 v26, 0x3fb8aa3b, v26
    v_exp_f32 v26, v26
    s_nop 0
    v_mov_b32 v28, v26
    v_cvt_pk_bf16_f32 v29, v26, v28
    v_lshlrev_b32 v26, 16, v29
    v_and_b32 v28, 0xffff0000, v29
    v_cvt_f32_u32 v30, v3
    v_mul_f32 v31, 16.0, v30
    v_add_f32 v32, v26, v26
    v_sub_f32 v33, 0, v32
    v_mov_b32 v100, 0
    v_mov_b32 v64, 0
    v_mov_b32 v101, 0
    v_mov_b32 v65, 0
    v_mov_b32 v102, 0
    v_mov_b32 v66, 0
    v_mov_b32 v103, 0
    v_mov_b32 v67, 0
    v_mov_b32 v104, 0
    v_mov_b32 v68, 0
    v_mov_b32 v105, 0
    v_mov_b32 v69, 0
    v_mov_b32 v106, 0
    v_mov_b32 v70, 0
    v_mov_b32 v107, 0
    v_mov_b32 v71, 0
    v_mov_b32 v108, 0
    v_mov_b32 v72, 0
    v_mov_b32 v109, 0
    v_mov_b32 v73, 0
    v_mov_b32 v110, 0
    v_mov_b32 v74, 0
    v_mov_b32 v111, 0
    v_mov_b32 v75, 0
    v_mov_b32 v112, 0
    v_mov_b32 v76, 0
    v_mov_b32 v113, 0
    v_mov_b32 v77, 0
    v_mov_b32 v114, 0
    v_mov_b32 v78, 0
    v_mov_b32 v115, 0
    v_mov_b32 v79, 0
    v_mov_b32 v116, 0
    v_lshlrev_b32 v40, 16, v10
    v_lshlrev_b32 v41, 16, v14
    v_lshlrev_b32 v42, 16, v18
    v_lshlrev_b32 v43, 16, v22
    v_mul_f32 v40, 0x3fb8aa3b, v40
    v_exp_f32 v40, v40
    v_mul_f32 v41, v41, v26
    v_mov_b32 v44, v40
    v_cvt_pk_bf16_f32 v45, v40, v44
    v_lshlrev_b32 v40, 16, v45
    v_and_b32 v44, 0xffff0000, v45
    v_mul_f32 v40, v40, v26
    v_mul_f32 v40, 0xbfb8aa3b, v40
    v_mul_f32 v41, 0x3e22f983, v41
    v_mul_f32 v42, v42, v32
    v_mul_f32 v43, v43, v33
    v_mul_f32 v44, v40, v30
    v_mul_f32 v46, v41, v30
    v_mul_f32 v45, v40, v31
    v_mul_f32 v47, v41, v31
    v_exp_f32 v44, v44
    v_fract_f32 v46, v46
    v_exp_f32 v45, v45
    v_fract_f32 v47, v47
    v_cos_f32 v48, v46
    v_cos_f32 v49, v47
    v_sin_f32 v50, v46
    v_sin_f32 v51, v47
    s_nop 0
    v_pk_mul_f32 v[48:49], v[48:49], v[44:45]
    v_pk_mul_f32 v[50:51], v[50:51], v[44:45]
    v_pk_mul_f32 v[52:53], v[48:49], v[42:43] op_sel:[1,0] op_sel_hi:[1,1]
    v_pk_fma_f32 v[52:53], v[50:51], v[42:43], v[52:53] op_sel:[1,1,0] op_sel_hi:[1,0,1] neg_hi:[0,1,0]
    v_pk_mul_f32 v[54:55], v[48:49], v[48:49]
    v_pk_mul_f32 v[58:59], v[48:49], v[50:51]
    v_mfma_f32_16x16x4_f32 v[100:103], v52, v48, v[100:103]
    v_pk_fma_f32 v[54:55], v[50:51], v[50:51], v[54:55] neg_lo:[1,0,0] neg_hi:[1,0,0]
    v_pk_add_f32 v[58:59], v[58:59], v[58:59]
    v_mfma_f32_16x16x4_f32 v[64:67], v53, v50, v[64:67]
    v_pk_mul_f32 v[52:53], v[54:55], v[42:43] op_sel:[1,0] op_sel_hi:[1,1]
    v_pk_fma_f32 v[52:53], v[58:59], v[42:43], v[52:53] op_sel:[1,1,0] op_sel_hi:[1,0,1] neg_hi:[0,1,0]
    v_pk_mul_f32 v[48:49], v[54:55], v[54:55]
    v_pk_mul_f32 v[50:51], v[54:55], v[58:59]
    v_mfma_f32_16x16x4_f32 v[104:107], v52, v54, v[104:107]
    v_pk_fma_f32 v[48:49], v[58:59], v[58:59], v[48:49] neg_lo:[1,0,0] neg_hi:[1,0,0]
    v_pk_add_f32 v[50:51], v[50:51], v[50:51]
    v_mfma_f32_16x16x4_f32 v[68:71], v53, v58, v[68:71]
    v_pk_mul_f32 v[52:53], v[48:49], v[42:43] op_sel:[1,0] op_sel_hi:[1,1]
    v_pk_fma_f32 v[52:53], v[50:51], v[42:43], v[52:53] op_sel:[1,1,0] op_sel_hi:[1,0,1] neg_hi:[0,1,0]
    v_pk_mul_f32 v[54:55], v[48:49], v[48:49]
    v_pk_mul_f32 v[58:59], v[48:49], v[50:51]
    v_mfma_f32_16x16x4_f32 v[108:111], v52, v48, v[108:111]
    v_pk_fma_f32 v[54:55], v[50:51], v[50:51], v[54:55] neg_lo:[1,0,0] neg_hi:[1,0,0]
    v_pk_add_f32 v[58:59], v[58:59], v[58:59]
    v_mfma_f32_16x16x4_f32 v[72:75], v53, v50, v[72:75]
    v_pk_mul_f32 v[52:53], v[54:55], v[42:43] op_sel:[1,0] op_sel_hi:[1,1]
    v_pk_fma_f32 v[52:53], v[58:59], v[42:43], v[52:53] op_sel:[1,1,0] op_sel_hi:[1,0,1] neg_hi:[0,1,0]
    v_pk_mul_f32 v[48:49], v[54:55], v[54:55]
    v_pk_mul_f32 v[50:51], v[54:55], v[58:59]
    v_mfma_f32_16x16x4_f32 v[112:115], v52, v54, v[112:115]
    v_pk_fma_f32 v[48:49], v[58:59], v[58:59], v[48:49] neg_lo:[1,0,0] neg_hi:[1,0,0]
    v_pk_add_f32 v[50:51], v[50:51], v[50:51]
    v_mfma_f32_16x16x4_f32 v[76:79], v53, v58, v[76:79]
    v_mul_f32 v52, v49, v42
    v_fma_f32 v52, v51, v43, v52
    v_add_f32 v116, v116, v52
    v_and_b32 v40, 0xffff0000, v10
    v_and_b32 v41, 0xffff0000, v14
    v_and_b32 v42, 0xffff0000, v18
    v_and_b32 v43, 0xffff0000, v22
    v_mul_f32 v40, 0x3fb8aa3b, v40
    v_exp_f32 v40, v40
    v_mul_f32 v41, v41, v26
    v_mov_b32 v44, v40
    v_cvt_pk_bf16_f32 v45, v40, v44
    v_lshlrev_b32 v40, 16, v45
    v_and_b32 v44, 0xffff0000, v45
    v_mul_f32 v40, v40, v26
    v_mul_f32 v40, 0xbfb8aa3b, v40
    v_mul_f32 v41, 0x3e22f983, v41
    v_mul_f32 v42, v42, v32
    v_mul_f32 v43, v43, v33
    v_mul_f32 v44, v40, v30
    v_mul_f32 v46, v41, v30
    v_mul_f32 v45, v40, v31
    v_mul_f32 v47, v41, v31
    v_exp_f32 v44, v44
    v_fract_f32 v46, v46
    v_exp_f32 v45, v45
    v_fract_f32 v47, v47
    v_cos_f32 v48, v46
    v_cos_f32 v49, v47
    v_sin_f32 v50, v46
    v_sin_f32 v51, v47
    s_nop 0
    v_pk_mul_f32 v[48:49], v[48:49], v[44:45]
    v_pk_mul_f32 v[50:51], v[50:51], v[44:45]
    v_pk_mul_f32 v[52:53], v[48:49], v[42:43] op_sel:[1,0] op_sel_hi:[1,1]
    v_pk_fma_f32 v[52:53], v[50:51], v[42:43], v[52:53] op_sel:[1,1,0] op_sel_hi:[1,0,1] neg_hi:[0,1,0]
    v_pk_mul_f32 v[54:55], v[48:49], v[48:49]
    v_pk_mul_f32 v[58:59], v[48:49], v[50:51]
    v_mfma_f32_16x16x4_f32 v[100:103], v52, v48, v[100:103]
    v_pk_fma_f32 v[54:55], v[50:51], v[50:51], v[54:55] neg_lo:[1,0,0] neg_hi:[1,0,0]
    v_pk_add_f32 v[58:59], v[58:59], v[58:59]
    v_mfma_f32_16x16x4_f32 v[64:67], v53, v50, v[64:67]
    v_pk_mul_f32 v[52:53], v[54:55], v[42:43] op_sel:[1,0] op_sel_hi:[1,1]
    v_pk_fma_f32 v[52:53], v[58:59], v[42:43], v[52:53] op_sel:[1,1,0] op_sel_hi:[1,0,1] neg_hi:[0,1,0]
    v_pk_mul_f32 v[48:49], v[54:55], v[54:55]
    v_pk_mul_f32 v[50:51], v[54:55], v[58:59]
    v_mfma_f32_16x16x4_f32 v[104:107], v52, v54, v[104:107]
    v_pk_fma_f32 v[48:49], v[58:59], v[58:59], v[48:49] neg_lo:[1,0,0] neg_hi:[1,0,0]
    v_pk_add_f32 v[50:51], v[50:51], v[50:51]
    v_mfma_f32_16x16x4_f32 v[68:71], v53, v58, v[68:71]
    v_pk_mul_f32 v[52:53], v[48:49], v[42:43] op_sel:[1,0] op_sel_hi:[1,1]
    v_pk_fma_f32 v[52:53], v[50:51], v[42:43], v[52:53] op_sel:[1,1,0] op_sel_hi:[1,0,1] neg_hi:[0,1,0]
    v_pk_mul_f32 v[54:55], v[48:49], v[48:49]
    v_pk_mul_f32 v[58:59], v[48:49], v[50:51]
    v_mfma_f32_16x16x4_f32 v[108:111], v52, v48, v[108:111]
    v_pk_fma_f32 v[54:55], v[50:51], v[50:51], v[54:55] neg_lo:[1,0,0] neg_hi:[1,0,0]
    v_pk_add_f32 v[58:59], v[58:59], v[58:59]
    v_mfma_f32_16x16x4_f32 v[72:75], v53, v50, v[72:75]
    v_pk_mul_f32 v[52:53], v[54:55], v[42:43] op_sel:[1,0] op_sel_hi:[1,1]
    v_pk_fma_f32 v[52:53], v[58:59], v[42:43], v[52:53] op_sel:[1,1,0] op_sel_hi:[1,0,1] neg_hi:[0,1,0]
    v_pk_mul_f32 v[48:49], v[54:55], v[54:55]
    v_pk_mul_f32 v[50:51], v[54:55], v[58:59]
    v_mfma_f32_16x16x4_f32 v[112:115], v52, v54, v[112:115]
    v_pk_fma_f32 v[48:49], v[58:59], v[58:59], v[48:49] neg_lo:[1,0,0] neg_hi:[1,0,0]
    v_pk_add_f32 v[50:51], v[50:51], v[50:51]
    v_mfma_f32_16x16x4_f32 v[76:79], v53, v58, v[76:79]
    v_mul_f32 v52, v49, v42
    v_fma_f32 v52, v51, v43, v52
    v_add_f32 v116, v116, v52
    v_lshlrev_b32 v40, 16, v11
    v_lshlrev_b32 v41, 16, v15
    v_lshlrev_b32 v42, 16, v19
    v_lshlrev_b32 v43, 16, v23
    v_mul_f32 v40, 0x3fb8aa3b, v40
    v_exp_f32 v40, v40
    v_mul_f32 v41, v41, v26
    v_mov_b32 v44, v40
    v_cvt_pk_bf16_f32 v45, v40, v44
    v_lshlrev_b32 v40, 16, v45
    v_and_b32 v44, 0xffff0000, v45
    v_mul_f32 v40, v40, v26
    v_mul_f32 v40, 0xbfb8aa3b, v40
    v_mul_f32 v41, 0x3e22f983, v41
    v_mul_f32 v42, v42, v32
    v_mul_f32 v43, v43, v33
    v_mul_f32 v44, v40, v30
    v_mul_f32 v46, v41, v30
    v_mul_f32 v45, v40, v31
    v_mul_f32 v47, v41, v31
    v_exp_f32 v44, v44
    v_fract_f32 v46, v46
    v_exp_f32 v45, v45
    v_fract_f32 v47, v47
    v_cos_f32 v48, v46
    v_cos_f32 v49, v47
    v_sin_f32 v50, v46
    v_sin_f32 v51, v47
    s_nop 0
    v_pk_mul_f32 v[48:49], v[48:49], v[44:45]
    v_pk_mul_f32 v[50:51], v[50:51], v[44:45]
    v_pk_mul_f32 v[52:53], v[48:49], v[42:43] op_sel:[1,0] op_sel_hi:[1,1]
    v_pk_fma_f32 v[52:53], v[50:51], v[42:43], v[52:53] op_sel:[1,1,0] op_sel_hi:[1,0,1] neg_hi:[0,1,0]
    v_pk_mul_f32 v[54:55], v[48:49], v[48:49]
    v_pk_mul_f32 v[58:59], v[48:49], v[50:51]
    v_mfma_f32_16x16x4_f32 v[100:103], v52, v48, v[100:103]
    v_pk_fma_f32 v[54:55], v[50:51], v[50:51], v[54:55] neg_lo:[1,0,0] neg_hi:[1,0,0]
    v_pk_add_f32 v[58:59], v[58:59], v[58:59]
    v_mfma_f32_16x16x4_f32 v[64:67], v53, v50, v[64:67]
    v_pk_mul_f32 v[52:53], v[54:55], v[42:43] op_sel:[1,0] op_sel_hi:[1,1]
    v_pk_fma_f32 v[52:53], v[58:59], v[42:43], v[52:53] op_sel:[1,1,0] op_sel_hi:[1,0,1] neg_hi:[0,1,0]
    v_pk_mul_f32 v[48:49], v[54:55], v[54:55]
    v_pk_mul_f32 v[50:51], v[54:55], v[58:59]
    v_mfma_f32_16x16x4_f32 v[104:107], v52, v54, v[104:107]
    v_pk_fma_f32 v[48:49], v[58:59], v[58:59], v[48:49] neg_lo:[1,0,0] neg_hi:[1,0,0]
    v_pk_add_f32 v[50:51], v[50:51], v[50:51]
    v_mfma_f32_16x16x4_f32 v[68:71], v53, v58, v[68:71]
    v_pk_mul_f32 v[52:53], v[48:49], v[42:43] op_sel:[1,0] op_sel_hi:[1,1]
    v_pk_fma_f32 v[52:53], v[50:51], v[42:43], v[52:53] op_sel:[1,1,0] op_sel_hi:[1,0,1] neg_hi:[0,1,0]
    v_pk_mul_f32 v[54:55], v[48:49], v[48:49]
    v_pk_mul_f32 v[58:59], v[48:49], v[50:51]
    v_mfma_f32_16x16x4_f32 v[108:111], v52, v48, v[108:111]
    v_pk_fma_f32 v[54:55], v[50:51], v[50:51], v[54:55] neg_lo:[1,0,0] neg_hi:[1,0,0]
    v_pk_add_f32 v[58:59], v[58:59], v[58:59]
    v_mfma_f32_16x16x4_f32 v[72:75], v53, v50, v[72:75]
    v_pk_mul_f32 v[52:53], v[54:55], v[42:43] op_sel:[1,0] op_sel_hi:[1,1]
    v_pk_fma_f32 v[52:53], v[58:59], v[42:43], v[52:53] op_sel:[1,1,0] op_sel_hi:[1,0,1] neg_hi:[0,1,0]
    v_pk_mul_f32 v[48:49], v[54:55], v[54:55]
    v_pk_mul_f32 v[50:51], v[54:55], v[58:59]
    v_mfma_f32_16x16x4_f32 v[112:115], v52, v54, v[112:115]
    v_pk_fma_f32 v[48:49], v[58:59], v[58:59], v[48:49] neg_lo:[1,0,0] neg_hi:[1,0,0]
    v_pk_add_f32 v[50:51], v[50:51], v[50:51]
    v_mfma_f32_16x16x4_f32 v[76:79], v53, v58, v[76:79]
    v_mul_f32 v52, v49, v42
    v_fma_f32 v52, v51, v43, v52
    v_add_f32 v116, v116, v52
    v_and_b32 v40, 0xffff0000, v11
    v_and_b32 v41, 0xffff0000, v15
    v_and_b32 v42, 0xffff0000, v19
    v_and_b32 v43, 0xffff0000, v23
    v_mul_f32 v40, 0x3fb8aa3b, v40
    v_exp_f32 v40, v40
    v_mul_f32 v41, v41, v26
    v_mov_b32 v44, v40
    v_cvt_pk_bf16_f32 v45, v40, v44
    v_lshlrev_b32 v40, 16, v45
    v_and_b32 v44, 0xffff0000, v45
    v_mul_f32 v40, v40, v26
    v_mul_f32 v40, 0xbfb8aa3b, v40
    v_mul_f32 v41, 0x3e22f983, v41
    v_mul_f32 v42, v42, v32
    v_mul_f32 v43, v43, v33
    v_mul_f32 v44, v40, v30
    v_mul_f32 v46, v41, v30
    v_mul_f32 v45, v40, v31
    v_mul_f32 v47, v41, v31
    v_exp_f32 v44, v44
    v_fract_f32 v46, v46
    v_exp_f32 v45, v45
    v_fract_f32 v47, v47
    v_cos_f32 v48, v46
    v_cos_f32 v49, v47
    v_sin_f32 v50, v46
    v_sin_f32 v51, v47
    s_nop 0
    v_pk_mul_f32 v[48:49], v[48:49], v[44:45]
    v_pk_mul_f32 v[50:51], v[50:51], v[44:45]
    v_pk_mul_f32 v[52:53], v[48:49], v[42:43] op_sel:[1,0] op_sel_hi:[1,1]
    v_pk_fma_f32 v[52:53], v[50:51], v[42:43], v[52:53] op_sel:[1,1,0] op_sel_hi:[1,0,1] neg_hi:[0,1,0]
    v_pk_mul_f32 v[54:55], v[48:49], v[48:49]
    v_pk_mul_f32 v[58:59], v[48:49], v[50:51]
    v_mfma_f32_16x16x4_f32 v[100:103], v52, v48, v[100:103]
    v_pk_fma_f32 v[54:55], v[50:51], v[50:51], v[54:55] neg_lo:[1,0,0] neg_hi:[1,0,0]
    v_pk_add_f32 v[58:59], v[58:59], v[58:59]
    v_mfma_f32_16x16x4_f32 v[64:67], v53, v50, v[64:67]
    v_pk_mul_f32 v[52:53], v[54:55], v[42:43] op_sel:[1,0] op_sel_hi:[1,1]
    v_pk_fma_f32 v[52:53], v[58:59], v[42:43], v[52:53] op_sel:[1,1,0] op_sel_hi:[1,0,1] neg_hi:[0,1,0]
    v_pk_mul_f32 v[48:49], v[54:55], v[54:55]
    v_pk_mul_f32 v[50:51], v[54:55], v[58:59]
    v_mfma_f32_16x16x4_f32 v[104:107], v52, v54, v[104:107]
    v_pk_fma_f32 v[48:49], v[58:59], v[58:59], v[48:49] neg_lo:[1,0,0] neg_hi:[1,0,0]
    v_pk_add_f32 v[50:51], v[50:51], v[50:51]
    v_mfma_f32_16x16x4_f32 v[68:71], v53, v58, v[68:71]
    v_pk_mul_f32 v[52:53], v[48:49], v[42:43] op_sel:[1,0] op_sel_hi:[1,1]
    v_pk_fma_f32 v[52:53], v[50:51], v[42:43], v[52:53] op_sel:[1,1,0] op_sel_hi:[1,0,1] neg_hi:[0,1,0]
    v_pk_mul_f32 v[54:55], v[48:49], v[48:49]
    v_pk_mul_f32 v[58:59], v[48:49], v[50:51]
    v_mfma_f32_16x16x4_f32 v[108:111], v52, v48, v[108:111]
    v_pk_fma_f32 v[54:55], v[50:51], v[50:51], v[54:55] neg_lo:[1,0,0] neg_hi:[1,0,0]
    v_pk_add_f32 v[58:59], v[58:59], v[58:59]
    v_mfma_f32_16x16x4_f32 v[72:75], v53, v50, v[72:75]
    v_pk_mul_f32 v[52:53], v[54:55], v[42:43] op_sel:[1,0] op_sel_hi:[1,1]
    v_pk_fma_f32 v[52:53], v[58:59], v[42:43], v[52:53] op_sel:[1,1,0] op_sel_hi:[1,0,1] neg_hi:[0,1,0]
    v_pk_mul_f32 v[48:49], v[54:55], v[54:55]
    v_pk_mul_f32 v[50:51], v[54:55], v[58:59]
    v_mfma_f32_16x16x4_f32 v[112:115], v52, v54, v[112:115]
    v_pk_fma_f32 v[48:49], v[58:59], v[58:59], v[48:49] neg_lo:[1,0,0] neg_hi:[1,0,0]
    v_pk_add_f32 v[50:51], v[50:51], v[50:51]
    v_mfma_f32_16x16x4_f32 v[76:79], v53, v58, v[76:79]
    v_mul_f32 v52, v49, v42
    v_fma_f32 v52, v51, v43, v52
    v_add_f32 v116, v116, v52
    v_lshlrev_b32 v40, 16, v12
    v_lshlrev_b32 v41, 16, v16
    v_lshlrev_b32 v42, 16, v20
    v_lshlrev_b32 v43, 16, v24
    v_mul_f32 v40, 0x3fb8aa3b, v40
    v_exp_f32 v40, v40
    v_mul_f32 v41, v41, v26
    v_mov_b32 v44, v40
    v_cvt_pk_bf16_f32 v45, v40, v44
    v_lshlrev_b32 v40, 16, v45
    v_and_b32 v44, 0xffff0000, v45
    v_mul_f32 v40, v40, v26
    v_mul_f32 v40, 0xbfb8aa3b, v40
    v_mul_f32 v41, 0x3e22f983, v41
    v_mul_f32 v42, v42, v32
    v_mul_f32 v43, v43, v33
    v_mul_f32 v44, v40, v30
    v_mul_f32 v46, v41, v30
    v_mul_f32 v45, v40, v31
    v_mul_f32 v47, v41, v31
    v_exp_f32 v44, v44
    v_fract_f32 v46, v46
    v_exp_f32 v45, v45
    v_fract_f32 v47, v47
    v_cos_f32 v48, v46
    v_cos_f32 v49, v47
    v_sin_f32 v50, v46
    v_sin_f32 v51, v47
    s_nop 0
    v_pk_mul_f32 v[48:49], v[48:49], v[44:45]
    v_pk_mul_f32 v[50:51], v[50:51], v[44:45]
    v_pk_mul_f32 v[52:53], v[48:49], v[42:43] op_sel:[1,0] op_sel_hi:[1,1]
    v_pk_fma_f32 v[52:53], v[50:51], v[42:43], v[52:53] op_sel:[1,1,0] op_sel_hi:[1,0,1] neg_hi:[0,1,0]
    v_pk_mul_f32 v[54:55], v[48:49], v[48:49]
    v_pk_mul_f32 v[58:59], v[48:49], v[50:51]
    v_mfma_f32_16x16x4_f32 v[100:103], v52, v48, v[100:103]
    v_pk_fma_f32 v[54:55], v[50:51], v[50:51], v[54:55] neg_lo:[1,0,0] neg_hi:[1,0,0]
    v_pk_add_f32 v[58:59], v[58:59], v[58:59]
    v_mfma_f32_16x16x4_f32 v[64:67], v53, v50, v[64:67]
    v_pk_mul_f32 v[52:53], v[54:55], v[42:43] op_sel:[1,0] op_sel_hi:[1,1]
    v_pk_fma_f32 v[52:53], v[58:59], v[42:43], v[52:53] op_sel:[1,1,0] op_sel_hi:[1,0,1] neg_hi:[0,1,0]
    v_pk_mul_f32 v[48:49], v[54:55], v[54:55]
    v_pk_mul_f32 v[50:51], v[54:55], v[58:59]
    v_mfma_f32_16x16x4_f32 v[104:107], v52, v54, v[104:107]
    v_pk_fma_f32 v[48:49], v[58:59], v[58:59], v[48:49] neg_lo:[1,0,0] neg_hi:[1,0,0]
    v_pk_add_f32 v[50:51], v[50:51], v[50:51]
    v_mfma_f32_16x16x4_f32 v[68:71], v53, v58, v[68:71]
    v_pk_mul_f32 v[52:53], v[48:49], v[42:43] op_sel:[1,0] op_sel_hi:[1,1]
    v_pk_fma_f32 v[52:53], v[50:51], v[42:43], v[52:53] op_sel:[1,1,0] op_sel_hi:[1,0,1] neg_hi:[0,1,0]
    v_pk_mul_f32 v[54:55], v[48:49], v[48:49]
    v_pk_mul_f32 v[58:59], v[48:49], v[50:51]
    v_mfma_f32_16x16x4_f32 v[108:111], v52, v48, v[108:111]
    v_pk_fma_f32 v[54:55], v[50:51], v[50:51], v[54:55] neg_lo:[1,0,0] neg_hi:[1,0,0]
    v_pk_add_f32 v[58:59], v[58:59], v[58:59]
    v_mfma_f32_16x16x4_f32 v[72:75], v53, v50, v[72:75]
    v_pk_mul_f32 v[52:53], v[54:55], v[42:43] op_sel:[1,0] op_sel_hi:[1,1]
    v_pk_fma_f32 v[52:53], v[58:59], v[42:43], v[52:53] op_sel:[1,1,0] op_sel_hi:[1,0,1] neg_hi:[0,1,0]
    v_pk_mul_f32 v[48:49], v[54:55], v[54:55]
    v_pk_mul_f32 v[50:51], v[54:55], v[58:59]
    v_mfma_f32_16x16x4_f32 v[112:115], v52, v54, v[112:115]
    v_pk_fma_f32 v[48:49], v[58:59], v[58:59], v[48:49] neg_lo:[1,0,0] neg_hi:[1,0,0]
    v_pk_add_f32 v[50:51], v[50:51], v[50:51]
    v_mfma_f32_16x16x4_f32 v[76:79], v53, v58, v[76:79]
    v_mul_f32 v52, v49, v42
    v_fma_f32 v52, v51, v43, v52
    v_add_f32 v116, v116, v52
    v_and_b32 v40, 0xffff0000, v12
    v_and_b32 v41, 0xffff0000, v16
    v_and_b32 v42, 0xffff0000, v20
    v_and_b32 v43, 0xffff0000, v24
    v_mul_f32 v40, 0x3fb8aa3b, v40
    v_exp_f32 v40, v40
    v_mul_f32 v41, v41, v26
    v_mov_b32 v44, v40
    v_cvt_pk_bf16_f32 v45, v40, v44
    v_lshlrev_b32 v40, 16, v45
    v_and_b32 v44, 0xffff0000, v45
    v_mul_f32 v40, v40, v26
    v_mul_f32 v40, 0xbfb8aa3b, v40
    v_mul_f32 v41, 0x3e22f983, v41
    v_mul_f32 v42, v42, v32
    v_mul_f32 v43, v43, v33
    v_mul_f32 v44, v40, v30
    v_mul_f32 v46, v41, v30
    v_mul_f32 v45, v40, v31
    v_mul_f32 v47, v41, v31
    v_exp_f32 v44, v44
    v_fract_f32 v46, v46
    v_exp_f32 v45, v45
    v_fract_f32 v47, v47
    v_cos_f32 v48, v46
    v_cos_f32 v49, v47
    v_sin_f32 v50, v46
    v_sin_f32 v51, v47
    s_nop 0
    v_pk_mul_f32 v[48:49], v[48:49], v[44:45]
    v_pk_mul_f32 v[50:51], v[50:51], v[44:45]
    v_pk_mul_f32 v[52:53], v[48:49], v[42:43] op_sel:[1,0] op_sel_hi:[1,1]
    v_pk_fma_f32 v[52:53], v[50:51], v[42:43], v[52:53] op_sel:[1,1,0] op_sel_hi:[1,0,1] neg_hi:[0,1,0]
    v_pk_mul_f32 v[54:55], v[48:49], v[48:49]
    v_pk_mul_f32 v[58:59], v[48:49], v[50:51]
    v_mfma_f32_16x16x4_f32 v[100:103], v52, v48, v[100:103]
    v_pk_fma_f32 v[54:55], v[50:51], v[50:51], v[54:55] neg_lo:[1,0,0] neg_hi:[1,0,0]
    v_pk_add_f32 v[58:59], v[58:59], v[58:59]
    v_mfma_f32_16x16x4_f32 v[64:67], v53, v50, v[64:67]
    v_pk_mul_f32 v[52:53], v[54:55], v[42:43] op_sel:[1,0] op_sel_hi:[1,1]
    v_pk_fma_f32 v[52:53], v[58:59], v[42:43], v[52:53] op_sel:[1,1,0] op_sel_hi:[1,0,1] neg_hi:[0,1,0]
    v_pk_mul_f32 v[48:49], v[54:55], v[54:55]
    v_pk_mul_f32 v[50:51], v[54:55], v[58:59]
    v_mfma_f32_16x16x4_f32 v[104:107], v52, v54, v[104:107]
    v_pk_fma_f32 v[48:49], v[58:59], v[58:59], v[48:49] neg_lo:[1,0,0] neg_hi:[1,0,0]
    v_pk_add_f32 v[50:51], v[50:51], v[50:51]
    v_mfma_f32_16x16x4_f32 v[68:71], v53, v58, v[68:71]
    v_pk_mul_f32 v[52:53], v[48:49], v[42:43] op_sel:[1,0] op_sel_hi:[1,1]
    v_pk_fma_f32 v[52:53], v[50:51], v[42:43], v[52:53] op_sel:[1,1,0] op_sel_hi:[1,0,1] neg_hi:[0,1,0]
    v_pk_mul_f32 v[54:55], v[48:49], v[48:49]
    v_pk_mul_f32 v[58:59], v[48:49], v[50:51]
    v_mfma_f32_16x16x4_f32 v[108:111], v52, v48, v[108:111]
    v_pk_fma_f32 v[54:55], v[50:51], v[50:51], v[54:55] neg_lo:[1,0,0] neg_hi:[1,0,0]
    v_pk_add_f32 v[58:59], v[58:59], v[58:59]
    v_mfma_f32_16x16x4_f32 v[72:75], v53, v50, v[72:75]
    v_pk_mul_f32 v[52:53], v[54:55], v[42:43] op_sel:[1,0] op_sel_hi:[1,1]
    v_pk_fma_f32 v[52:53], v[58:59], v[42:43], v[52:53] op_sel:[1,1,0] op_sel_hi:[1,0,1] neg_hi:[0,1,0]
    v_pk_mul_f32 v[48:49], v[54:55], v[54:55]
    v_pk_mul_f32 v[50:51], v[54:55], v[58:59]
    v_mfma_f32_16x16x4_f32 v[112:115], v52, v54, v[112:115]
    v_pk_fma_f32 v[48:49], v[58:59], v[58:59], v[48:49] neg_lo:[1,0,0] neg_hi:[1,0,0]
    v_pk_add_f32 v[50:51], v[50:51], v[50:51]
    v_mfma_f32_16x16x4_f32 v[76:79], v53, v58, v[76:79]
    v_mul_f32 v52, v49, v42
    v_fma_f32 v52, v51, v43, v52
    v_add_f32 v116, v116, v52
    v_lshlrev_b32 v40, 16, v13
    v_lshlrev_b32 v41, 16, v17
    v_lshlrev_b32 v42, 16, v21
    v_lshlrev_b32 v43, 16, v25
    v_mul_f32 v40, 0x3fb8aa3b, v40
    v_exp_f32 v40, v40
    v_mul_f32 v41, v41, v26
    v_mov_b32 v44, v40
    v_cvt_pk_bf16_f32 v45, v40, v44
    v_lshlrev_b32 v40, 16, v45
    v_and_b32 v44, 0xffff0000, v45
    v_mul_f32 v40, v40, v26
    v_mul_f32 v40, 0xbfb8aa3b, v40
    v_mul_f32 v41, 0x3e22f983, v41
    v_mul_f32 v42, v42, v32
    v_mul_f32 v43, v43, v33
    v_mul_f32 v44, v40, v30
    v_mul_f32 v46, v41, v30
    v_mul_f32 v45, v40, v31
    v_mul_f32 v47, v41, v31
    v_exp_f32 v44, v44
    v_fract_f32 v46, v46
    v_exp_f32 v45, v45
    v_fract_f32 v47, v47
    v_cos_f32 v48, v46
    v_cos_f32 v49, v47
    v_sin_f32 v50, v46
    v_sin_f32 v51, v47
    s_nop 0
    v_pk_mul_f32 v[48:49], v[48:49], v[44:45]
    v_pk_mul_f32 v[50:51], v[50:51], v[44:45]
    v_pk_mul_f32 v[52:53], v[48:49], v[42:43] op_sel:[1,0] op_sel_hi:[1,1]
    v_pk_fma_f32 v[52:53], v[50:51], v[42:43], v[52:53] op_sel:[1,1,0] op_sel_hi:[1,0,1] neg_hi:[0,1,0]
    v_pk_mul_f32 v[54:55], v[48:49], v[48:49]
    v_pk_mul_f32 v[58:59], v[48:49], v[50:51]
    v_mfma_f32_16x16x4_f32 v[100:103], v52, v48, v[100:103]
    v_pk_fma_f32 v[54:55], v[50:51], v[50:51], v[54:55] neg_lo:[1,0,0] neg_hi:[1,0,0]
    v_pk_add_f32 v[58:59], v[58:59], v[58:59]
    v_mfma_f32_16x16x4_f32 v[64:67], v53, v50, v[64:67]
    v_pk_mul_f32 v[52:53], v[54:55], v[42:43] op_sel:[1,0] op_sel_hi:[1,1]
    v_pk_fma_f32 v[52:53], v[58:59], v[42:43], v[52:53] op_sel:[1,1,0] op_sel_hi:[1,0,1] neg_hi:[0,1,0]
    v_pk_mul_f32 v[48:49], v[54:55], v[54:55]
    v_pk_mul_f32 v[50:51], v[54:55], v[58:59]
    v_mfma_f32_16x16x4_f32 v[104:107], v52, v54, v[104:107]
    v_pk_fma_f32 v[48:49], v[58:59], v[58:59], v[48:49] neg_lo:[1,0,0] neg_hi:[1,0,0]
    v_pk_add_f32 v[50:51], v[50:51], v[50:51]
    v_mfma_f32_16x16x4_f32 v[68:71], v53, v58, v[68:71]
    v_pk_mul_f32 v[52:53], v[48:49], v[42:43] op_sel:[1,0] op_sel_hi:[1,1]
    v_pk_fma_f32 v[52:53], v[50:51], v[42:43], v[52:53] op_sel:[1,1,0] op_sel_hi:[1,0,1] neg_hi:[0,1,0]
    v_pk_mul_f32 v[54:55], v[48:49], v[48:49]
    v_pk_mul_f32 v[58:59], v[48:49], v[50:51]
    v_mfma_f32_16x16x4_f32 v[108:111], v52, v48, v[108:111]
    v_pk_fma_f32 v[54:55], v[50:51], v[50:51], v[54:55] neg_lo:[1,0,0] neg_hi:[1,0,0]
    v_pk_add_f32 v[58:59], v[58:59], v[58:59]
    v_mfma_f32_16x16x4_f32 v[72:75], v53, v50, v[72:75]
    v_pk_mul_f32 v[52:53], v[54:55], v[42:43] op_sel:[1,0] op_sel_hi:[1,1]
    v_pk_fma_f32 v[52:53], v[58:59], v[42:43], v[52:53] op_sel:[1,1,0] op_sel_hi:[1,0,1] neg_hi:[0,1,0]
    v_pk_mul_f32 v[48:49], v[54:55], v[54:55]
    v_pk_mul_f32 v[50:51], v[54:55], v[58:59]
    v_mfma_f32_16x16x4_f32 v[112:115], v52, v54, v[112:115]
    v_pk_fma_f32 v[48:49], v[58:59], v[58:59], v[48:49] neg_lo:[1,0,0] neg_hi:[1,0,0]
    v_pk_add_f32 v[50:51], v[50:51], v[50:51]
    v_mfma_f32_16x16x4_f32 v[76:79], v53, v58, v[76:79]
    v_mul_f32 v52, v49, v42
    v_fma_f32 v52, v51, v43, v52
    v_add_f32 v116, v116, v52
    v_and_b32 v40, 0xffff0000, v13
    v_and_b32 v41, 0xffff0000, v17
    v_and_b32 v42, 0xffff0000, v21
    v_and_b32 v43, 0xffff0000, v25
    v_mul_f32 v40, 0x3fb8aa3b, v40
    v_exp_f32 v40, v40
    v_mul_f32 v41, v41, v26
    v_mov_b32 v44, v40
    v_cvt_pk_bf16_f32 v45, v40, v44
    v_lshlrev_b32 v40, 16, v45
    v_and_b32 v44, 0xffff0000, v45
    v_mul_f32 v40, v40, v26
    v_mul_f32 v40, 0xbfb8aa3b, v40
    v_mul_f32 v41, 0x3e22f983, v41
    v_mul_f32 v42, v42, v32
    v_mul_f32 v43, v43, v33
    v_mul_f32 v44, v40, v30
    v_mul_f32 v46, v41, v30
    v_mul_f32 v45, v40, v31
    v_mul_f32 v47, v41, v31
    v_exp_f32 v44, v44
    v_fract_f32 v46, v46
    v_exp_f32 v45, v45
    v_fract_f32 v47, v47
    v_cos_f32 v48, v46
    v_cos_f32 v49, v47
    v_sin_f32 v50, v46
    v_sin_f32 v51, v47
    s_nop 0
    v_pk_mul_f32 v[48:49], v[48:49], v[44:45]
    v_pk_mul_f32 v[50:51], v[50:51], v[44:45]
    v_pk_mul_f32 v[52:53], v[48:49], v[42:43] op_sel:[1,0] op_sel_hi:[1,1]
    v_pk_fma_f32 v[52:53], v[50:51], v[42:43], v[52:53] op_sel:[1,1,0] op_sel_hi:[1,0,1] neg_hi:[0,1,0]
    v_pk_mul_f32 v[54:55], v[48:49], v[48:49]
    v_pk_mul_f32 v[58:59], v[48:49], v[50:51]
    v_mfma_f32_16x16x4_f32 v[100:103], v52, v48, v[100:103]
    v_pk_fma_f32 v[54:55], v[50:51], v[50:51], v[54:55] neg_lo:[1,0,0] neg_hi:[1,0,0]
    v_pk_add_f32 v[58:59], v[58:59], v[58:59]
    v_mfma_f32_16x16x4_f32 v[64:67], v53, v50, v[64:67]
    v_pk_mul_f32 v[52:53], v[54:55], v[42:43] op_sel:[1,0] op_sel_hi:[1,1]
    v_pk_fma_f32 v[52:53], v[58:59], v[42:43], v[52:53] op_sel:[1,1,0] op_sel_hi:[1,0,1] neg_hi:[0,1,0]
    v_pk_mul_f32 v[48:49], v[54:55], v[54:55]
    v_pk_mul_f32 v[50:51], v[54:55], v[58:59]
    v_mfma_f32_16x16x4_f32 v[104:107], v52, v54, v[104:107]
    v_pk_fma_f32 v[48:49], v[58:59], v[58:59], v[48:49] neg_lo:[1,0,0] neg_hi:[1,0,0]
    v_pk_add_f32 v[50:51], v[50:51], v[50:51]
    v_mfma_f32_16x16x4_f32 v[68:71], v53, v58, v[68:71]
    v_pk_mul_f32 v[52:53], v[48:49], v[42:43] op_sel:[1,0] op_sel_hi:[1,1]
    v_pk_fma_f32 v[52:53], v[50:51], v[42:43], v[52:53] op_sel:[1,1,0] op_sel_hi:[1,0,1] neg_hi:[0,1,0]
    v_pk_mul_f32 v[54:55], v[48:49], v[48:49]
    v_pk_mul_f32 v[58:59], v[48:49], v[50:51]
    v_mfma_f32_16x16x4_f32 v[108:111], v52, v48, v[108:111]
    v_pk_fma_f32 v[54:55], v[50:51], v[50:51], v[54:55] neg_lo:[1,0,0] neg_hi:[1,0,0]
    v_pk_add_f32 v[58:59], v[58:59], v[58:59]
    v_mfma_f32_16x16x4_f32 v[72:75], v53, v50, v[72:75]
    v_pk_mul_f32 v[52:53], v[54:55], v[42:43] op_sel:[1,0] op_sel_hi:[1,1]
    v_pk_fma_f32 v[52:53], v[58:59], v[42:43], v[52:53] op_sel:[1,1,0] op_sel_hi:[1,0,1] neg_hi:[0,1,0]
    v_pk_mul_f32 v[48:49], v[54:55], v[54:55]
    v_pk_mul_f32 v[50:51], v[54:55], v[58:59]
    v_mfma_f32_16x16x4_f32 v[112:115], v52, v54, v[112:115]
    v_pk_fma_f32 v[48:49], v[58:59], v[58:59], v[48:49] neg_lo:[1,0,0] neg_hi:[1,0,0]
    v_pk_add_f32 v[50:51], v[50:51], v[50:51]
    v_mfma_f32_16x16x4_f32 v[76:79], v53, v58, v[76:79]
    v_mul_f32 v52, v49, v42
    v_fma_f32 v52, v51, v43, v52
    v_add_f32 v116, v116, v52
    s_nop 15
    v_add_f32 v100, v100, v64
    v_add_f32 v101, v101, v65
    v_add_f32 v102, v102, v66
    v_add_f32 v103, v103, v67
    v_add_f32 v104, v104, v68
    v_add_f32 v105, v105, v69
    v_add_f32 v106, v106, v70
    v_add_f32 v107, v107, v71
    v_add_f32 v108, v108, v72
    v_add_f32 v109, v109, v73
    v_add_f32 v110, v110, v74
    v_add_f32 v111, v111, v75
    v_add_f32 v112, v112, v76
    v_add_f32 v113, v113, v77
    v_add_f32 v114, v114, v78
    v_add_f32 v115, v115, v79
    s_nop 15
    s_lshl_b32 s19, s18, 12
    v_lshlrev_b32 v5, 8, v4
    v_lshl_add_u32 v5, v3, 2, v5
    v_add_u32 v5, s19, v5
    ds_write_b32 v5, v100 offset:0
    ds_write_b32 v5, v101 offset:64
    ds_write_b32 v5, v102 offset:128
    ds_write_b32 v5, v103 offset:192
    ds_write_b32 v5, v104 offset:1024
    ds_write_b32 v5, v105 offset:1088
    ds_write_b32 v5, v106 offset:1152
    ds_write_b32 v5, v107 offset:1216
    ds_write_b32 v5, v108 offset:2048
    ds_write_b32 v5, v109 offset:2112
    ds_write_b32 v5, v110 offset:2176
    ds_write_b32 v5, v111 offset:2240
    ds_write_b32 v5, v112 offset:3072
    ds_write_b32 v5, v113 offset:3136
    ds_write_b32 v5, v114 offset:3200
    ds_write_b32 v5, v115 offset:3264
    s_lshl_b32 s19, s18, 4
    v_lshlrev_b32 v6, 2, v4
    v_add_u32 v6, s19, v6
    v_cmp_eq_u32 vcc, 8, v3
    s_and_saveexec_b64 s[54:55], vcc
    v_add_u32 v6, 71680, v6
    ds_write_b32 v6, v116
    s_mov_b64 exec, s[54:55]
    s_waitcnt lgkmcnt(0)
    s_barrier
    v_lshlrev_b32 v5, 4, v0
    ds_read_b128 v[40:43], v5
    ds_read_b128 v[44:47], v5 offset:4096
    ds_read_b128 v[48:51], v5 offset:8192
    ds_read_b128 v[52:55], v5 offset:12288
    v_mov_b32 v6, 71680
    ds_read_b128 v[56:59], v6
    ds_read_b128 v[60:63], v6 offset:16
    ds_read_b128 v[64:67], v6 offset:32
    ds_read_b128 v[68:71], v6 offset:48
    s_waitcnt lgkmcnt(0)
    v_add_f32 v40, v40, v44
    v_add_f32 v48, v48, v52
    v_add_f32 v40, v40, v48
    v_add_f32 v41, v41, v45
    v_add_f32 v49, v49, v53
    v_add_f32 v41, v41, v49
    v_add_f32 v42, v42, v46
    v_add_f32 v50, v50, v54
    v_add_f32 v42, v42, v50
    v_add_f32 v43, v43, v47
    v_add_f32 v51, v51, v55
    v_add_f32 v43, v43, v51
    v_add_f32 v56, v56, v57
    v_add_f32 v56, v56, v58
    v_add_f32 v56, v56, v59
    v_add_f32 v56, v56, v60
    v_add_f32 v56, v56, v61
    v_add_f32 v56, v56, v62
    v_add_f32 v56, v56, v63
    v_add_f32 v56, v56, v64
    v_add_f32 v56, v56, v65
    v_add_f32 v56, v56, v66
    v_add_f32 v56, v56, v67
    v_add_f32 v56, v56, v68
    v_add_f32 v56, v56, v69
    v_add_f32 v56, v56, v70
    v_add_f32 v56, v56, v71
    v_add_u32 v5, 66560, v5
    ds_write_b128 v5, v[40:43]
    v_mov_b32 v57, 0
    v_mov_b32 v6, 71168
    v_cmp_eq_u32 vcc, 0, v0
    s_and_saveexec_b64 s[54:55], vcc
    ds_write_b32 v6, v56
    ds_write_b32 v6, v57 offset:4
    s_mov_b64 exec, s[54:55]
    s_waitcnt lgkmcnt(0)
    s_barrier
    v_lshlrev_b32 v5, 3, v0
    v_sub_u32 v5, 2047, v5
    v_mov_b32 v9, 71172
    s_mov_b32 s56, 0x7fff
    v_subrev_u32 v6, 0, v5
    v_max_i32 v7, 0, v6
    v_cvt_f32_u32 v7, v7
    v_bfe_u32 v8, v7, 16, 1
    v_add3_u32 v7, v7, v8, s56
    v_and_b32 v7, 0xffff0000, v7
    v_cvt_u32_f32 v8, v7
    v_lshrrev_b32 v7, 23, v7
    v_subrev_u32 v7, 134, v7
    v_max_i32 v7, 0, v7
    v_lshrrev_b32 v8, v7, v8
    v_lshl_add_u32 v8, v7, 8, v8
    v_lshlrev_b32 v8, 2, v8
    v_add_u32 v8, 66560, v8
    v_cmp_gt_i32 vcc, 0, v6
    s_nop 1
    v_cndmask_b32 v8, v8, v9, vcc
    ds_read_b32 v40, v8
    v_subrev_u32 v6, 1, v5
    v_max_i32 v7, 0, v6
    v_cvt_f32_u32 v7, v7
    v_bfe_u32 v8, v7, 16, 1
    v_add3_u32 v7, v7, v8, s56
    v_and_b32 v7, 0xffff0000, v7
    v_cvt_u32_f32 v8, v7
    v_lshrrev_b32 v7, 23, v7
    v_subrev_u32 v7, 134, v7
    v_max_i32 v7, 0, v7
    v_lshrrev_b32 v8, v7, v8
    v_lshl_add_u32 v8, v7, 8, v8
    v_lshlrev_b32 v8, 2, v8
    v_add_u32 v8, 66560, v8
    v_cmp_gt_i32 vcc, 0, v6
    s_nop 1
    v_cndmask_b32 v8, v8, v9, vcc
    ds_read_b32 v41, v8
    v_subrev_u32 v6, 2, v5
    v_max_i32 v7, 0, v6
    v_cvt_f32_u32 v7, v7
    v_bfe_u32 v8, v7, 16, 1
    v_add3_u32 v7, v7, v8, s56
    v_and_b32 v7, 0xffff0000, v7
    v_cvt_u32_f32 v8, v7
    v_lshrrev_b32 v7, 23, v7
    v_subrev_u32 v7, 134, v7
    v_max_i32 v7, 0, v7
    v_lshrrev_b32 v8, v7, v8
    v_lshl_add_u32 v8, v7, 8, v8
    v_lshlrev_b32 v8, 2, v8
    v_add_u32 v8, 66560, v8
    v_cmp_gt_i32 vcc, 0, v6
    s_nop 1
    v_cndmask_b32 v8, v8, v9, vcc
    ds_read_b32 v42, v8
    v_subrev_u32 v6, 3, v5
    v_max_i32 v7, 0, v6
    v_cvt_f32_u32 v7, v7
    v_bfe_u32 v8, v7, 16, 1
    v_add3_u32 v7, v7, v8, s56
    v_and_b32 v7, 0xffff0000, v7
    v_cvt_u32_f32 v8, v7
    v_lshrrev_b32 v7, 23, v7
    v_subrev_u32 v7, 134, v7
    v_max_i32 v7, 0, v7
    v_lshrrev_b32 v8, v7, v8
    v_lshl_add_u32 v8, v7, 8, v8
    v_lshlrev_b32 v8, 2, v8
    v_add_u32 v8, 66560, v8
    v_cmp_gt_i32 vcc, 0, v6
    s_nop 1
    v_cndmask_b32 v8, v8, v9, vcc
    ds_read_b32 v43, v8
    v_subrev_u32 v6, 4, v5
    v_max_i32 v7, 0, v6
    v_cvt_f32_u32 v7, v7
    v_bfe_u32 v8, v7, 16, 1
    v_add3_u32 v7, v7, v8, s56
    v_and_b32 v7, 0xffff0000, v7
    v_cvt_u32_f32 v8, v7
    v_lshrrev_b32 v7, 23, v7
    v_subrev_u32 v7, 134, v7
    v_max_i32 v7, 0, v7
    v_lshrrev_b32 v8, v7, v8
    v_lshl_add_u32 v8, v7, 8, v8
    v_lshlrev_b32 v8, 2, v8
    v_add_u32 v8, 66560, v8
    v_cmp_gt_i32 vcc, 0, v6
    s_nop 1
    v_cndmask_b32 v8, v8, v9, vcc
    ds_read_b32 v44, v8
    v_subrev_u32 v6, 5, v5
    v_max_i32 v7, 0, v6
    v_cvt_f32_u32 v7, v7
    v_bfe_u32 v8, v7, 16, 1
    v_add3_u32 v7, v7, v8, s56
    v_and_b32 v7, 0xffff0000, v7
    v_cvt_u32_f32 v8, v7
    v_lshrrev_b32 v7, 23, v7
    v_subrev_u32 v7, 134, v7
    v_max_i32 v7, 0, v7
    v_lshrrev_b32 v8, v7, v8
    v_lshl_add_u32 v8, v7, 8, v8
    v_lshlrev_b32 v8, 2, v8
    v_add_u32 v8, 66560, v8
    v_cmp_gt_i32 vcc, 0, v6
    s_nop 1
    v_cndmask_b32 v8, v8, v9, vcc
    ds_read_b32 v45, v8
    v_subrev_u32 v6, 6, v5
    v_max_i32 v7, 0, v6
    v_cvt_f32_u32 v7, v7
    v_bfe_u32 v8, v7, 16, 1
    v_add3_u32 v7, v7, v8, s56
    v_and_b32 v7, 0xffff0000, v7
    v_cvt_u32_f32 v8, v7
    v_lshrrev_b32 v7, 23, v7
    v_subrev_u32 v7, 134, v7
    v_max_i32 v7, 0, v7
    v_lshrrev_b32 v8, v7, v8
    v_lshl_add_u32 v8, v7, 8, v8
    v_lshlrev_b32 v8, 2, v8
    v_add_u32 v8, 66560, v8
    v_cmp_gt_i32 vcc, 0, v6
    s_nop 1
    v_cndmask_b32 v8, v8, v9, vcc
    ds_read_b32 v46, v8
    v_subrev_u32 v6, 7, v5
    v_max_i32 v7, 0, v6
    v_cvt_f32_u32 v7, v7
    v_bfe_u32 v8, v7, 16, 1
    v_add3_u32 v7, v7, v8, s56
    v_and_b32 v7, 0xffff0000, v7
    v_cvt_u32_f32 v8, v7
    v_lshrrev_b32 v7, 23, v7
    v_subrev_u32 v7, 134, v7
    v_max_i32 v7, 0, v7
    v_lshrrev_b32 v8, v7, v8
    v_lshl_add_u32 v8, v7, 8, v8
    v_lshlrev_b32 v8, 2, v8
    v_add_u32 v8, 66560, v8
    v_cmp_gt_i32 vcc, 0, v6
    s_nop 1
    v_cndmask_b32 v8, v8, v9, vcc
    ds_read_b32 v47, v8
    v_subrev_u32 v6, 8, v5
    v_max_i32 v7, 0, v6
    v_cvt_f32_u32 v7, v7
    v_bfe_u32 v8, v7, 16, 1
    v_add3_u32 v7, v7, v8, s56
    v_and_b32 v7, 0xffff0000, v7
    v_cvt_u32_f32 v8, v7
    v_lshrrev_b32 v7, 23, v7
    v_subrev_u32 v7, 134, v7
    v_max_i32 v7, 0, v7
    v_lshrrev_b32 v8, v7, v8
    v_lshl_add_u32 v8, v7, 8, v8
    v_lshlrev_b32 v8, 2, v8
    v_add_u32 v8, 66560, v8
    v_cmp_gt_i32 vcc, 0, v6
    s_nop 1
    v_cndmask_b32 v8, v8, v9, vcc
    ds_read_b32 v48, v8
    v_subrev_u32 v6, 9, v5
    v_max_i32 v7, 0, v6
    v_cvt_f32_u32 v7, v7
    v_bfe_u32 v8, v7, 16, 1
    v_add3_u32 v7, v7, v8, s56
    v_and_b32 v7, 0xffff0000, v7
    v_cvt_u32_f32 v8, v7
    v_lshrrev_b32 v7, 23, v7
    v_subrev_u32 v7, 134, v7
    v_max_i32 v7, 0, v7
    v_lshrrev_b32 v8, v7, v8
    v_lshl_add_u32 v8, v7, 8, v8
    v_lshlrev_b32 v8, 2, v8
    v_add_u32 v8, 66560, v8
    v_cmp_gt_i32 vcc, 0, v6
    s_nop 1
    v_cndmask_b32 v8, v8, v9, vcc
    ds_read_b32 v49, v8
    v_subrev_u32 v6, 10, v5
    v_max_i32 v7, 0, v6
    v_cvt_f32_u32 v7, v7
    v_bfe_u32 v8, v7, 16, 1
    v_add3_u32 v7, v7, v8, s56
    v_and_b32 v7, 0xffff0000, v7
    v_cvt_u32_f32 v8, v7
    v_lshrrev_b32 v7, 23, v7
    v_subrev_u32 v7, 134, v7
    v_max_i32 v7, 0, v7
    v_lshrrev_b32 v8, v7, v8
    v_lshl_add_u32 v8, v7, 8, v8
    v_lshlrev_b32 v8, 2, v8
    v_add_u32 v8, 66560, v8
    v_cmp_gt_i32 vcc, 0, v6
    s_nop 1
    v_cndmask_b32 v8, v8, v9, vcc
    ds_read_b32 v50, v8
    v_subrev_u32 v6, 11, v5
    v_max_i32 v7, 0, v6
    v_cvt_f32_u32 v7, v7
    v_bfe_u32 v8, v7, 16, 1
    v_add3_u32 v7, v7, v8, s56
    v_and_b32 v7, 0xffff0000, v7
    v_cvt_u32_f32 v8, v7
    v_lshrrev_b32 v7, 23, v7
    v_subrev_u32 v7, 134, v7
    v_max_i32 v7, 0, v7
    v_lshrrev_b32 v8, v7, v8
    v_lshl_add_u32 v8, v7, 8, v8
    v_lshlrev_b32 v8, 2, v8
    v_add_u32 v8, 66560, v8
    v_cmp_gt_i32 vcc, 0, v6
    s_nop 1
    v_cndmask_b32 v8, v8, v9, vcc
    ds_read_b32 v51, v8
    v_subrev_u32 v6, 12, v5
    v_max_i32 v7, 0, v6
    v_cvt_f32_u32 v7, v7
    v_bfe_u32 v8, v7, 16, 1
    v_add3_u32 v7, v7, v8, s56
    v_and_b32 v7, 0xffff0000, v7
    v_cvt_u32_f32 v8, v7
    v_lshrrev_b32 v7, 23, v7
    v_subrev_u32 v7, 134, v7
    v_max_i32 v7, 0, v7
    v_lshrrev_b32 v8, v7, v8
    v_lshl_add_u32 v8, v7, 8, v8
    v_lshlrev_b32 v8, 2, v8
    v_add_u32 v8, 66560, v8
    v_cmp_gt_i32 vcc, 0, v6
    s_nop 1
    v_cndmask_b32 v8, v8, v9, vcc
    ds_read_b32 v52, v8
    v_subrev_u32 v6, 13, v5
    v_max_i32 v7, 0, v6
    v_cvt_f32_u32 v7, v7
    v_bfe_u32 v8, v7, 16, 1
    v_add3_u32 v7, v7, v8, s56
    v_and_b32 v7, 0xffff0000, v7
    v_cvt_u32_f32 v8, v7
    v_lshrrev_b32 v7, 23, v7
    v_subrev_u32 v7, 134, v7
    v_max_i32 v7, 0, v7
    v_lshrrev_b32 v8, v7, v8
    v_lshl_add_u32 v8, v7, 8, v8
    v_lshlrev_b32 v8, 2, v8
    v_add_u32 v8, 66560, v8
    v_cmp_gt_i32 vcc, 0, v6
    s_nop 1
    v_cndmask_b32 v8, v8, v9, vcc
    ds_read_b32 v53, v8
    v_subrev_u32 v6, 14, v5
    v_max_i32 v7, 0, v6
    v_cvt_f32_u32 v7, v7
    v_bfe_u32 v8, v7, 16, 1
    v_add3_u32 v7, v7, v8, s56
    v_and_b32 v7, 0xffff0000, v7
    v_cvt_u32_f32 v8, v7
    v_lshrrev_b32 v7, 23, v7
    v_subrev_u32 v7, 134, v7
    v_max_i32 v7, 0, v7
    v_lshrrev_b32 v8, v7, v8
    v_lshl_add_u32 v8, v7, 8, v8
    v_lshlrev_b32 v8, 2, v8
    v_add_u32 v8, 66560, v8
    v_cmp_gt_i32 vcc, 0, v6
    s_nop 1
    v_cndmask_b32 v8, v8, v9, vcc
    ds_read_b32 v54, v8
    s_waitcnt lgkmcnt(0)
    v_lshlrev_b32 v5, 4, v0
    v_cvt_pk_bf16_f32 v60, v40, v41
    v_cvt_pk_bf16_f32 v78, v41, v42
    v_cvt_pk_bf16_f32 v61, v42, v43
    v_cvt_pk_bf16_f32 v79, v43, v44
    v_cvt_pk_bf16_f32 v62, v44, v45
    v_cvt_pk_bf16_f32 v80, v45, v46
    v_cvt_pk_bf16_f32 v63, v46, v47
    v_cvt_pk_bf16_f32 v81, v47, v48
    v_cvt_pk_bf16_f32 v64, v48, v49
    v_cvt_pk_bf16_f32 v82, v49, v50
    v_cvt_pk_bf16_f32 v65, v50, v51
    v_cvt_pk_bf16_f32 v83, v51, v52
    v_cvt_pk_bf16_f32 v66, v52, v53
    v_cvt_pk_bf16_f32 v84, v53, v54
    v_mov_b32 v69, v60
    v_mov_b32 v87, v78
    v_mov_b32 v70, v61
    v_mov_b32 v88, v79
    v_mov_b32 v71, v62
    v_mov_b32 v89, v80
    v_mov_b32 v72, v63
    v_mov_b32 v90, v81
    v_mov_b32 v73, v64
    v_mov_b32 v91, v82
    v_mov_b32 v74, v65
    v_mov_b32 v92, v83
    v_mov_b32 v75, v66
    v_mov_b32 v93, v84
    ds_write_b128 v5, v[60:63] offset:0
    ds_write_b128 v5, v[78:81] offset:4160
    ds_write_b128 v5, v[70:73] offset:8320
    ds_write_b128 v5, v[88:91] offset:12480
    ds_write_b128 v5, v[62:65] offset:16640
    ds_write_b128 v5, v[80:83] offset:20800
    ds_write_b128 v5, v[72:75] offset:24960
    ds_write_b128 v5, v[90:93] offset:29120
    v_lshlrev_b32 v6, 16, v60
    v_and_b32 v7, 0xffff0000, v60
    v_sub_f32 v40, v40, v6
    v_sub_f32 v41, v41, v7
    v_lshlrev_b32 v6, 16, v61
    v_and_b32 v7, 0xffff0000, v61
    v_sub_f32 v42, v42, v6
    v_sub_f32 v43, v43, v7
    v_lshlrev_b32 v6, 16, v62
    v_and_b32 v7, 0xffff0000, v62
    v_sub_f32 v44, v44, v6
    v_sub_f32 v45, v45, v7
    v_lshlrev_b32 v6, 16, v63
    v_and_b32 v7, 0xffff0000, v63
    v_sub_f32 v46, v46, v6
    v_sub_f32 v47, v47, v7
    v_lshlrev_b32 v6, 16, v64
    v_and_b32 v7, 0xffff0000, v64
    v_sub_f32 v48, v48, v6
    v_sub_f32 v49, v49, v7
    v_lshlrev_b32 v6, 16, v65
    v_and_b32 v7, 0xffff0000, v65
    v_sub_f32 v50, v50, v6
    v_sub_f32 v51, v51, v7
    v_lshlrev_b32 v6, 16, v66
    v_and_b32 v7, 0xffff0000, v66
    v_sub_f32 v52, v52, v6
    v_sub_f32 v53, v53, v7
    v_and_b32 v7, 0xffff0000, v84
    v_sub_f32 v54, v54, v7
    s_waitcnt lgkmcnt(0)
    v_cvt_pk_bf16_f32 v60, v40, v41
    v_cvt_pk_bf16_f32 v78, v41, v42
    v_cvt_pk_bf16_f32 v61, v42, v43
    v_cvt_pk_bf16_f32 v79, v43, v44
    v_cvt_pk_bf16_f32 v62, v44, v45
    v_cvt_pk_bf16_f32 v80, v45, v46
    v_cvt_pk_bf16_f32 v63, v46, v47
    v_cvt_pk_bf16_f32 v81, v47, v48
    v_cvt_pk_bf16_f32 v64, v48, v49
    v_cvt_pk_bf16_f32 v82, v49, v50
    v_cvt_pk_bf16_f32 v65, v50, v51
    v_cvt_pk_bf16_f32 v83, v51, v52
    v_cvt_pk_bf16_f32 v66, v52, v53
    v_cvt_pk_bf16_f32 v84, v53, v54
    v_mov_b32 v69, v60
    v_mov_b32 v87, v78
    v_mov_b32 v70, v61
    v_mov_b32 v88, v79
    v_mov_b32 v71, v62
    v_mov_b32 v89, v80
    v_mov_b32 v72, v63
    v_mov_b32 v90, v81
    v_mov_b32 v73, v64
    v_mov_b32 v91, v82
    v_mov_b32 v74, v65
    v_mov_b32 v92, v83
    v_mov_b32 v75, v66
    v_mov_b32 v93, v84
    ds_write_b128 v5, v[60:63] offset:33280
    ds_write_b128 v5, v[78:81] offset:37440
    ds_write_b128 v5, v[70:73] offset:41600
    ds_write_b128 v5, v[88:91] offset:45760
    ds_write_b128 v5, v[62:65] offset:49920
    ds_write_b128 v5, v[80:83] offset:54080
    ds_write_b128 v5, v[72:75] offset:58240
    ds_write_b128 v5, v[90:93] offset:62400
    v_mov_b32 v60, 0
    v_mov_b32 v61, 0
    v_mov_b32 v62, 0
    v_mov_b32 v63, 0
    v_mul_u32_u24 v6, 4160, v0
    v_cmp_gt_u32 vcc, 16, v0
    s_and_saveexec_b64 s[54:55], vcc
    ds_write_b128 v6, v[60:63] offset:4096
    s_mov_b64 exec, s[54:55]
    s_waitcnt vmcnt(0) lgkmcnt(0)
    s_barrier
    v_sub_u32 v5, 7, v3
    v_and_b32 v5, 7, v5
    v_lshrrev_b32 v6, 1, v4
    v_lshlrev_b32 v6, 4, v6
    v_and_b32 v7, 1, v4
    v_lshlrev_b32 v7, 3, v7
    v_sub_u32 v7, v7, v6
    v_sub_u32 v7, v7, v3
    v_sub_u32 v7, v7, v5
    s_lshl_b32 s19, s18, 5
    v_subrev_u32 v7, s19, v7
    v_add_u32 v7, 127, v7
    v_lshlrev_b32 v7, 1, v7
    v_mul_u32_u24 v5, 4160, v5
    v_add_u32 v5, v5, v7
    s_cmp_lg_u32 s57, 0
    s_cbranch_scc1 L_kc_nopf
    s_add_u32 s58, s2, 288
    s_lshl_b32 s19, s58, 8
    s_lshl_b32 s52, s18, 6
    s_add_u32 s19, s19, s52
    v_lshlrev_b32 v218, 4, v4
    v_add_u32 v218, s19, v218
    buffer_load_dwordx4 v[200:203], v218, s[20:23], 0 offen
    buffer_load_dwordx4 v[204:207], v218, s[24:27], 0 offen
    buffer_load_dwordx4 v[208:211], v218, s[28:31], 0 offen
    buffer_load_dwordx4 v[212:215], v218, s[32:35], 0 offen
    s_lshl_b32 s19, s58, 1
    v_mov_b32 v219, s19
    buffer_load_ushort v216, v219, s[36:39], 0 offen
    buffer_load_ushort v217, v219, s[40:43], 0 offen
L_kc_nopf:
    v_mov_b32 v64, 0
    v_mov_b32 v65, 0
    v_mov_b32 v66, 0
    v_mov_b32 v67, 0
    v_mov_b32 v68, 0
    v_mov_b32 v69, 0
    v_mov_b32 v70, 0
    v_mov_b32 v71, 0
    v_mov_b32 v72, 0
    v_mov_b32 v73, 0
    v_mov_b32 v74, 0
    v_mov_b32 v75, 0
    v_mov_b32 v76, 0
    v_mov_b32 v77, 0
    v_mov_b32 v78, 0
    v_mov_b32 v79, 0
    v_mov_b32 v80, 0
    v_mov_b32 v81, 0
    v_mov_b32 v82, 0
    v_mov_b32 v83, 0
    v_mov_b32 v84, 0
    v_mov_b32 v85, 0
    v_mov_b32 v86, 0
    v_mov_b32 v87, 0
    v_mov_b32 v88, 0
    v_mov_b32 v89, 0
    v_mov_b32 v90, 0
    v_mov_b32 v91, 0
    v_mov_b32 v92, 0
    v_mov_b32 v93, 0
    v_mov_b32 v94, 0
    v_mov_b32 v95, 0
    ds_read_b128 v[40:43], v5 offset:3840
    ds_read_b128 v[44:47], v5 offset:37120
    ds_read_b128 v[48:51], v5 offset:3584
    ds_read_b128 v[52:55], v5 offset:36864
    s_waitcnt lgkmcnt(2)
    v_mfma_f32_16x16x32_bf16 v[64:67], v[40:43], v[132:135], v[64:67]
    v_mfma_f32_16x16x32_bf16 v[68:71], v[40:43], v[140:143], v[68:71]
    v_mfma_f32_16x16x32_bf16 v[72:75], v[40:43], v[148:151], v[72:75]
    v_mfma_f32_16x16x32_bf16 v[76:79], v[40:43], v[156:159], v[76:79]
    v_mfma_f32_16x16x32_bf16 v[80:83], v[40:43], v[164:167], v[80:83]
    v_mfma_f32_16x16x32_bf16 v[84:87], v[40:43], v[172:175], v[84:87]
    v_mfma_f32_16x16x32_bf16 v[88:91], v[40:43], v[180:183], v[88:91]
    v_mfma_f32_16x16x32_bf16 v[92:95], v[40:43], v[188:191], v[92:95]
    v_mfma_f32_16x16x32_bf16 v[64:67], v[44:47], v[132:135], v[64:67]
    v_mfma_f32_16x16x32_bf16 v[68:71], v[44:47], v[140:143], v[68:71]
    v_mfma_f32_16x16x32_bf16 v[72:75], v[44:47], v[148:151], v[72:75]
    v_mfma_f32_16x16x32_bf16 v[76:79], v[44:47], v[156:159], v[76:79]
    v_mfma_f32_16x16x32_bf16 v[80:83], v[44:47], v[164:167], v[80:83]
    v_mfma_f32_16x16x32_bf16 v[84:87], v[44:47], v[172:175], v[84:87]
    v_mfma_f32_16x16x32_bf16 v[88:91], v[44:47], v[180:183], v[88:91]
    v_mfma_f32_16x16x32_bf16 v[92:95], v[44:47], v[188:191], v[92:95]
    ds_read_b128 v[40:43], v5 offset:3328
    ds_read_b128 v[44:47], v5 offset:36608
    s_waitcnt lgkmcnt(2)
    v_mfma_f32_16x16x32_bf16 v[64:67], v[48:51], v[128:131], v[64:67]
    v_mfma_f32_16x16x32_bf16 v[68:71], v[48:51], v[136:139], v[68:71]
    v_mfma_f32_16x16x32_bf16 v[72:75], v[48:51], v[144:147], v[72:75]
    v_mfma_f32_16x16x32_bf16 v[76:79], v[48:51], v[152:155], v[76:79]
    v_mfma_f32_16x16x32_bf16 v[80:83], v[48:51], v[160:163], v[80:83]
    v_mfma_f32_16x16x32_bf16 v[84:87], v[48:51], v[168:171], v[84:87]
    v_mfma_f32_16x16x32_bf16 v[88:91], v[48:51], v[176:179], v[88:91]
    v_mfma_f32_16x16x32_bf16 v[92:95], v[48:51], v[184:187], v[92:95]
    v_mfma_f32_16x16x32_bf16 v[64:67], v[52:55], v[128:131], v[64:67]
    v_mfma_f32_16x16x32_bf16 v[68:71], v[52:55], v[136:139], v[68:71]
    v_mfma_f32_16x16x32_bf16 v[72:75], v[52:55], v[144:147], v[72:75]
    v_mfma_f32_16x16x32_bf16 v[76:79], v[52:55], v[152:155], v[76:79]
    v_mfma_f32_16x16x32_bf16 v[80:83], v[52:55], v[160:163], v[80:83]
    v_mfma_f32_16x16x32_bf16 v[84:87], v[52:55], v[168:171], v[84:87]
    v_mfma_f32_16x16x32_bf16 v[88:91], v[52:55], v[176:179], v[88:91]
    v_mfma_f32_16x16x32_bf16 v[92:95], v[52:55], v[184:187], v[92:95]
    ds_read_b128 v[48:51], v5 offset:3072
    ds_read_b128 v[52:55], v5 offset:36352
    s_waitcnt lgkmcnt(2)
    v_mfma_f32_16x16x32_bf16 v[68:71], v[40:43], v[132:135], v[68:71]
    v_mfma_f32_16x16x32_bf16 v[72:75], v[40:43], v[140:143], v[72:75]
    v_mfma_f32_16x16x32_bf16 v[76:79], v[40:43], v[148:151], v[76:79]
    v_mfma_f32_16x16x32_bf16 v[80:83], v[40:43], v[156:159], v[80:83]
    v_mfma_f32_16x16x32_bf16 v[84:87], v[40:43], v[164:167], v[84:87]
    v_mfma_f32_16x16x32_bf16 v[88:91], v[40:43], v[172:175], v[88:91]
    v_mfma_f32_16x16x32_bf16 v[92:95], v[40:43], v[180:183], v[92:95]
    v_mfma_f32_16x16x32_bf16 v[68:71], v[44:47], v[132:135], v[68:71]
    v_mfma_f32_16x16x32_bf16 v[72:75], v[44:47], v[140:143], v[72:75]
    v_mfma_f32_16x16x32_bf16 v[76:79], v[44:47], v[148:151], v[76:79]
    v_mfma_f32_16x16x32_bf16 v[80:83], v[44:47], v[156:159], v[80:83]
    v_mfma_f32_16x16x32_bf16 v[84:87], v[44:47], v[164:167], v[84:87]
    v_mfma_f32_16x16x32_bf16 v[88:91], v[44:47], v[172:175], v[88:91]
    v_mfma_f32_16x16x32_bf16 v[92:95], v[44:47], v[180:183], v[92:95]
    ds_read_b128 v[40:43], v5 offset:2816
    ds_read_b128 v[44:47], v5 offset:36096
    s_waitcnt lgkmcnt(2)
    v_mfma_f32_16x16x32_bf16 v[68:71], v[48:51], v[128:131], v[68:71]
    v_mfma_f32_16x16x32_bf16 v[72:75], v[48:51], v[136:139], v[72:75]
    v_mfma_f32_16x16x32_bf16 v[76:79], v[48:51], v[144:147], v[76:79]
    v_mfma_f32_16x16x32_bf16 v[80:83], v[48:51], v[152:155], v[80:83]
    v_mfma_f32_16x16x32_bf16 v[84:87], v[48:51], v[160:163], v[84:87]
    v_mfma_f32_16x16x32_bf16 v[88:91], v[48:51], v[168:171], v[88:91]
    v_mfma_f32_16x16x32_bf16 v[92:95], v[48:51], v[176:179], v[92:95]
    v_mfma_f32_16x16x32_bf16 v[68:71], v[52:55], v[128:131], v[68:71]
    v_mfma_f32_16x16x32_bf16 v[72:75], v[52:55], v[136:139], v[72:75]
    v_mfma_f32_16x16x32_bf16 v[76:79], v[52:55], v[144:147], v[76:79]
    v_mfma_f32_16x16x32_bf16 v[80:83], v[52:55], v[152:155], v[80:83]
    v_mfma_f32_16x16x32_bf16 v[84:87], v[52:55], v[160:163], v[84:87]
    v_mfma_f32_16x16x32_bf16 v[88:91], v[52:55], v[168:171], v[88:91]
    v_mfma_f32_16x16x32_bf16 v[92:95], v[52:55], v[176:179], v[92:95]
    ds_read_b128 v[48:51], v5 offset:2560
    ds_read_b128 v[52:55], v5 offset:35840
    s_waitcnt lgkmcnt(2)
    v_mfma_f32_16x16x32_bf16 v[72:75], v[40:43], v[132:135], v[72:75]
    v_mfma_f32_16x16x32_bf16 v[76:79], v[40:43], v[140:143], v[76:79]
    v_mfma_f32_16x16x32_bf16 v[80:83], v[40:43], v[148:151], v[80:83]
    v_mfma_f32_16x16x32_bf16 v[84:87], v[40:43], v[156:159], v[84:87]
    v_mfma_f32_16x16x32_bf16 v[88:91], v[40:43], v[164:167], v[88:91]
    v_mfma_f32_16x16x32_bf16 v[92:95], v[40:43], v[172:175], v[92:95]
    v_mfma_f32_16x16x32_bf16 v[72:75], v[44:47], v[132:135], v[72:75]
    v_mfma_f32_16x16x32_bf16 v[76:79], v[44:47], v[140:143], v[76:79]
    v_mfma_f32_16x16x32_bf16 v[80:83], v[44:47], v[148:151], v[80:83]
    v_mfma_f32_16x16x32_bf16 v[84:87], v[44:47], v[156:159], v[84:87]
    v_mfma_f32_16x16x32_bf16 v[88:91], v[44:47], v[164:167], v[88:91]
    v_mfma_f32_16x16x32_bf16 v[92:95], v[44:47], v[172:175], v[92:95]
    ds_read_b128 v[40:43], v5 offset:2304
    ds_read_b128 v[44:47], v5 offset:35584
    s_waitcnt lgkmcnt(2)
    v_mfma_f32_16x16x32_bf16 v[72:75], v[48:51], v[128:131], v[72:75]
    v_mfma_f32_16x16x32_bf16 v[76:79], v[48:51], v[136:139], v[76:79]
    v_mfma_f32_16x16x32_bf16 v[80:83], v[48:51], v[144:147], v[80:83]
    v_mfma_f32_16x16x32_bf16 v[84:87], v[48:51], v[152:155], v[84:87]
    v_mfma_f32_16x16x32_bf16 v[88:91], v[48:51], v[160:163], v[88:91]
    v_mfma_f32_16x16x32_bf16 v[92:95], v[48:51], v[168:171], v[92:95]
    v_mfma_f32_16x16x32_bf16 v[72:75], v[52:55], v[128:131], v[72:75]
    v_mfma_f32_16x16x32_bf16 v[76:79], v[52:55], v[136:139], v[76:79]
    v_mfma_f32_16x16x32_bf16 v[80:83], v[52:55], v[144:147], v[80:83]
    v_mfma_f32_16x16x32_bf16 v[84:87], v[52:55], v[152:155], v[84:87]
    v_mfma_f32_16x16x32_bf16 v[88:91], v[52:55], v[160:163], v[88:91]
    v_mfma_f32_16x16x32_bf16 v[92:95], v[52:55], v[168:171], v[92:95]
    ds_read_b128 v[48:51], v5 offset:2048
    ds_read_b128 v[52:55], v5 offset:35328
    s_waitcnt lgkmcnt(2)
    v_mfma_f32_16x16x32_bf16 v[76:79], v[40:43], v[132:135], v[76:79]
    v_mfma_f32_16x16x32_bf16 v[80:83], v[40:43], v[140:143], v[80:83]
    v_mfma_f32_16x16x32_bf16 v[84:87], v[40:43], v[148:151], v[84:87]
    v_mfma_f32_16x16x32_bf16 v[88:91], v[40:43], v[156:159], v[88:91]
    v_mfma_f32_16x16x32_bf16 v[92:95], v[40:43], v[164:167], v[92:95]
    v_mfma_f32_16x16x32_bf16 v[76:79], v[44:47], v[132:135], v[76:79]
    v_mfma_f32_16x16x32_bf16 v[80:83], v[44:47], v[140:143], v[80:83]
    v_mfma_f32_16x16x32_bf16 v[84:87], v[44:47], v[148:151], v[84:87]
    v_mfma_f32_16x16x32_bf16 v[88:91], v[44:47], v[156:159], v[88:91]
    v_mfma_f32_16x16x32_bf16 v[92:95], v[44:47], v[164:167], v[92:95]
    ds_read_b128 v[40:43], v5 offset:1792
    ds_read_b128 v[44:47], v5 offset:35072
    s_waitcnt lgkmcnt(2)
    v_mfma_f32_16x16x32_bf16 v[76:79], v[48:51], v[128:131], v[76:79]
    v_mfma_f32_16x16x32_bf16 v[80:83], v[48:51], v[136:139], v[80:83]
    v_mfma_f32_16x16x32_bf16 v[84:87], v[48:51], v[144:147], v[84:87]
    v_mfma_f32_16x16x32_bf16 v[88:91], v[48:51], v[152:155], v[88:91]
    v_mfma_f32_16x16x32_bf16 v[92:95], v[48:51], v[160:163], v[92:95]
    v_mfma_f32_16x16x32_bf16 v[76:79], v[52:55], v[128:131], v[76:79]
    v_mfma_f32_16x16x32_bf16 v[80:83], v[52:55], v[136:139], v[80:83]
    v_mfma_f32_16x16x32_bf16 v[84:87], v[52:55], v[144:147], v[84:87]
    v_mfma_f32_16x16x32_bf16 v[88:91], v[52:55], v[152:155], v[88:91]
    v_mfma_f32_16x16x32_bf16 v[92:95], v[52:55], v[160:163], v[92:95]
    ds_read_b128 v[48:51], v5 offset:1536
    ds_read_b128 v[52:55], v5 offset:34816
    s_waitcnt lgkmcnt(2)
    v_mfma_f32_16x16x32_bf16 v[80:83], v[40:43], v[132:135], v[80:83]
    v_mfma_f32_16x16x32_bf16 v[84:87], v[40:43], v[140:143], v[84:87]
    v_mfma_f32_16x16x32_bf16 v[88:91], v[40:43], v[148:151], v[88:91]
    v_mfma_f32_16x16x32_bf16 v[92:95], v[40:43], v[156:159], v[92:95]
    v_mfma_f32_16x16x32_bf16 v[80:83], v[44:47], v[132:135], v[80:83]
    v_mfma_f32_16x16x32_bf16 v[84:87], v[44:47], v[140:143], v[84:87]
    v_mfma_f32_16x16x32_bf16 v[88:91], v[44:47], v[148:151], v[88:91]
    v_mfma_f32_16x16x32_bf16 v[92:95], v[44:47], v[156:159], v[92:95]
    ds_read_b128 v[40:43], v5 offset:1280
    ds_read_b128 v[44:47], v5 offset:34560
    s_waitcnt lgkmcnt(2)
    v_mfma_f32_16x16x32_bf16 v[80:83], v[48:51], v[128:131], v[80:83]
    v_mfma_f32_16x16x32_bf16 v[84:87], v[48:51], v[136:139], v[84:87]
    v_mfma_f32_16x16x32_bf16 v[88:91], v[48:51], v[144:147], v[88:91]
    v_mfma_f32_16x16x32_bf16 v[92:95], v[48:51], v[152:155], v[92:95]
    v_mfma_f32_16x16x32_bf16 v[80:83], v[52:55], v[128:131], v[80:83]
    v_mfma_f32_16x16x32_bf16 v[84:87], v[52:55], v[136:139], v[84:87]
    v_mfma_f32_16x16x32_bf16 v[88:91], v[52:55], v[144:147], v[88:91]
    v_mfma_f32_16x16x32_bf16 v[92:95], v[52:55], v[152:155], v[92:95]
    ds_read_b128 v[48:51], v5 offset:1024
    ds_read_b128 v[52:55], v5 offset:34304
    s_waitcnt lgkmcnt(2)
    v_mfma_f32_16x16x32_bf16 v[84:87], v[40:43], v[132:135], v[84:87]
    v_mfma_f32_16x16x32_bf16 v[88:91], v[40:43], v[140:143], v[88:91]
    v_mfma_f32_16x16x32_bf16 v[92:95], v[40:43], v[148:151], v[92:95]
    v_mfma_f32_16x16x32_bf16 v[84:87], v[44:47], v[132:135], v[84:87]
    v_mfma_f32_16x16x32_bf16 v[88:91], v[44:47], v[140:143], v[88:91]
    v_mfma_f32_16x16x32_bf16 v[92:95], v[44:47], v[148:151], v[92:95]
    ds_read_b128 v[40:43], v5 offset:768
    ds_read_b128 v[44:47], v5 offset:34048
    s_waitcnt lgkmcnt(2)
    v_mfma_f32_16x16x32_bf16 v[84:87], v[48:51], v[128:131], v[84:87]
    v_mfma_f32_16x16x32_bf16 v[88:91], v[48:51], v[136:139], v[88:91]
    v_mfma_f32_16x16x32_bf16 v[92:95], v[48:51], v[144:147], v[92:95]
    v_mfma_f32_16x16x32_bf16 v[84:87], v[52:55], v[128:131], v[84:87]
    v_mfma_f32_16x16x32_bf16 v[88:91], v[52:55], v[136:139], v[88:91]
    v_mfma_f32_16x16x32_bf16 v[92:95], v[52:55], v[144:147], v[92:95]
    ds_read_b128 v[48:51], v5 offset:512
    ds_read_b128 v[52:55], v5 offset:33792
    s_waitcnt lgkmcnt(2)
    v_mfma_f32_16x16x32_bf16 v[88:91], v[40:43], v[132:135], v[88:91]
    v_mfma_f32_16x16x32_bf16 v[92:95], v[40:43], v[140:143], v[92:95]
    v_mfma_f32_16x16x32_bf16 v[88:91], v[44:47], v[132:135], v[88:91]
    v_mfma_f32_16x16x32_bf16 v[92:95], v[44:47], v[140:143], v[92:95]
    ds_read_b128 v[40:43], v5 offset:256
    ds_read_b128 v[44:47], v5 offset:33536
    s_waitcnt lgkmcnt(2)
    v_mfma_f32_16x16x32_bf16 v[88:91], v[48:51], v[128:131], v[88:91]
    v_mfma_f32_16x16x32_bf16 v[92:95], v[48:51], v[136:139], v[92:95]
    v_mfma_f32_16x16x32_bf16 v[88:91], v[52:55], v[128:131], v[88:91]
    v_mfma_f32_16x16x32_bf16 v[92:95], v[52:55], v[136:139], v[92:95]
    ds_read_b128 v[48:51], v5 offset:0
    ds_read_b128 v[52:55], v5 offset:33280
    s_waitcnt lgkmcnt(2)
    v_mfma_f32_16x16x32_bf16 v[92:95], v[40:43], v[132:135], v[92:95]
    v_mfma_f32_16x16x32_bf16 v[92:95], v[44:47], v[132:135], v[92:95]
    s_waitcnt lgkmcnt(0)
    v_mfma_f32_16x16x32_bf16 v[92:95], v[48:51], v[128:131], v[92:95]
    v_mfma_f32_16x16x32_bf16 v[92:95], v[52:55], v[128:131], v[92:95]
    s_nop 15
    s_barrier
    v_lshlrev_b32 v5, 6, v3
    v_lshl_add_u32 v5, v4, 4, v5
    s_lshl_b32 s19, s18, 13
    v_add_u32 v5, s19, v5
    ds_write_b128 v5, v[64:67] offset:0
    ds_write_b128 v5, v[68:71] offset:1024
    ds_write_b128 v5, v[72:75] offset:2048
    ds_write_b128 v5, v[76:79] offset:3072
    ds_write_b128 v5, v[80:83] offset:4096
    ds_write_b128 v5, v[84:87] offset:5120
    ds_write_b128 v5, v[88:91] offset:6144
    ds_write_b128 v5, v[92:95] offset:7168
    s_waitcnt lgkmcnt(0)
    s_barrier
    v_lshlrev_b32 v5, 5, v0
    ds_read_b128 v[40:43], v5 offset:0
    ds_read_b128 v[44:47], v5 offset:16
    ds_read_b128 v[48:51], v5 offset:8192
    ds_read_b128 v[52:55], v5 offset:8208
    ds_read_b128 v[56:59], v5 offset:16384
    ds_read_b128 v[60:63], v5 offset:16400
    ds_read_b128 v[64:67], v5 offset:24576
    ds_read_b128 v[68:71], v5 offset:24592
    s_waitcnt lgkmcnt(0)
    v_add_f32 v40, v40, v48
    v_add_f32 v56, v56, v64
    v_add_f32 v40, v40, v56
    v_add_f32 v41, v41, v49
    v_add_f32 v57, v57, v65
    v_add_f32 v41, v41, v57
    v_add_f32 v42, v42, v50
    v_add_f32 v58, v58, v66
    v_add_f32 v42, v42, v58
    v_add_f32 v43, v43, v51
    v_add_f32 v59, v59, v67
    v_add_f32 v43, v43, v59
    v_add_f32 v44, v44, v52
    v_add_f32 v60, v60, v68
    v_add_f32 v44, v44, v60
    v_add_f32 v45, v45, v53
    v_add_f32 v61, v61, v69
    v_add_f32 v45, v45, v61
    v_add_f32 v46, v46, v54
    v_add_f32 v62, v62, v70
    v_add_f32 v46, v46, v62
    v_add_f32 v47, v47, v55
    v_add_f32 v63, v63, v71
    v_add_f32 v47, v47, v63
    v_cvt_pk_bf16_f32 v72, v40, v41
    v_lshlrev_b32 v40, 16, v72
    v_and_b32 v41, 0xffff0000, v72
    v_lshlrev_b32 v73, 16, v192
    v_and_b32 v74, 0xffff0000, v192
    v_mul_f32 v73, v73, v27
    v_mul_f32 v74, v74, v27
    v_cvt_pk_bf16_f32 v72, v73, v74
    v_lshlrev_b32 v73, 16, v72
    v_and_b32 v74, 0xffff0000, v72
    v_add_f32 v40, v40, v73
    v_add_f32 v41, v41, v74
    v_cvt_pk_bf16_f32 v76, v40, v41
    v_cvt_pk_bf16_f32 v72, v42, v43
    v_lshlrev_b32 v42, 16, v72
    v_and_b32 v43, 0xffff0000, v72
    v_lshlrev_b32 v73, 16, v193
    v_and_b32 v74, 0xffff0000, v193
    v_mul_f32 v73, v73, v27
    v_mul_f32 v74, v74, v27
    v_cvt_pk_bf16_f32 v72, v73, v74
    v_lshlrev_b32 v73, 16, v72
    v_and_b32 v74, 0xffff0000, v72
    v_add_f32 v42, v42, v73
    v_add_f32 v43, v43, v74
    v_cvt_pk_bf16_f32 v77, v42, v43
    v_cvt_pk_bf16_f32 v72, v44, v45
    v_lshlrev_b32 v44, 16, v72
    v_and_b32 v45, 0xffff0000, v72
    v_lshlrev_b32 v73, 16, v194
    v_and_b32 v74, 0xffff0000, v194
    v_mul_f32 v73, v73, v27
    v_mul_f32 v74, v74, v27
    v_cvt_pk_bf16_f32 v72, v73, v74
    v_lshlrev_b32 v73, 16, v72
    v_and_b32 v74, 0xffff0000, v72
    v_add_f32 v44, v44, v73
    v_add_f32 v45, v45, v74
    v_cvt_pk_bf16_f32 v78, v44, v45
    v_cvt_pk_bf16_f32 v72, v46, v47
    v_lshlrev_b32 v46, 16, v72
    v_and_b32 v47, 0xffff0000, v72
    v_lshlrev_b32 v73, 16, v195
    v_and_b32 v74, 0xffff0000, v195
    v_mul_f32 v73, v73, v27
    v_mul_f32 v74, v74, v27
    v_cvt_pk_bf16_f32 v72, v73, v74
    v_lshlrev_b32 v73, 16, v72
    v_and_b32 v74, 0xffff0000, v72
    v_add_f32 v46, v46, v73
    v_add_f32 v47, v47, v74
    v_cvt_pk_bf16_f32 v79, v46, v47
    v_lshlrev_b32 v5, 4, v0
    buffer_store_dwordx4 v[76:79], v5, s[48:51], 0 offen
    s_add_u32 s2, s2, 288
    s_add_u32 s57, s57, 1
    s_cmp_lt_u32 s57, 2
    s_barrier
    s_cbranch_scc1 L_kc_loop
L_kc_done:
    s_endpgm
.section .rodata,"a"
.p2align 6
.amdhsa_kernel mix_kernel
  .amdhsa_next_free_vgpr 232
  .amdhsa_next_free_sgpr 102
  .amdhsa_accum_offset 232
  .amdhsa_group_segment_fixed_size 0
  .amdhsa_kernarg_size 128
  .amdhsa_user_sgpr_count 2
  .amdhsa_user_sgpr_kernarg_segment_ptr 1
  .amdhsa_system_sgpr_workgroup_id_x 1
.end_amdhsa_kernel
.text
.globl gemm2_kernel
.p2align 8
.type gemm2_kernel,@function
gemm2_kernel:
    s_cmp_ge_u32 s2, 192
    s_cbranch_scc1 L_g2_done
    s_load_dwordx2 s[4:5], s[0:1], 80
    s_load_dwordx2 s[6:7], s[0:1], 88
    s_load_dwordx2 s[8:9], s[0:1], 104
    s_load_dwordx2 s[10:11], s[0:1], 120
    s_and_b32 s12, s2, 7
    s_lshr_b32 s13, s2, 3
    s_mul_i32 s12, s12, 24
    s_add_u32 s12, s12, s13
    s_mul_hi_u32 s13, s12, 0x2aaaaaab
    s_mul_i32 s14, s13, 6
    s_sub_u32 s14, s12, s14
    v_lshrrev_b32 v1, 6, v0
    v_and_b32 v2, 63, v0
    s_nop 0
    v_readfirstlane_b32 s15, v1
    s_waitcnt lgkmcnt(0)
    s_mov_b32 s16, s4
    s_mov_b32 s17, s5
    s_mov_b32 s18, 0x1200000
    s_mov_b32 s19, 0x00020000
    s_add_u32 s20, s10, 0x480000
    s_addc_u32 s21, s11, 0
    s_mov_b32 s22, 0x510000
    s_mov_b32 s23, 0x00020000
    s_mov_b32 s24, s6
    s_mov_b32 s25, s7
    s_mov_b32 s26, 0x1000
    s_mov_b32 s27, 0x00020000
    s_mov_b32 s28, s8
    s_mov_b32 s29, s9
    s_mov_b32 s30, 0x240000
    s_mov_b32 s31, 0x00020000
    s_add_u32 s48, s10, 0x990000
    s_addc_u32 s49, s11, 0
    s_mov_b32 s50, 0x240000
    s_mov_b32 s51, 0x00020000
    s_add_u32 s52, s10, 0xbd0000
    s_addc_u32 s53, s11, 0
    s_mov_b32 s54, 0x2000
    s_mov_b32 s55, 0x00020000
    v_lshrrev_b32 v3, 3, v2
    v_and_b32 v4, 7, v2
    v_lshrrev_b32 v5, 2, v4
    v_bfe_u32 v6, v2, 4, 1
    v_xor_b32 v5, v5, v6
    v_lshlrev_b32 v5, 6, v5
    v_and_b32 v6, 3, v2
    v_lshl_add_u32 v5, v6, 4, v5
    v_lshl_add_u32 v200, v3, 12, v5
    v_lshrrev_b32 v3, 4, v2
    v_and_b32 v4, 15, v2
    s_lshl_b32 s41, s15, 2
    v_add_u32 v5, s41, v3
    v_xor_b32 v5, v5, v4
    v_lshlrev_b32 v5, 4, v5
    v_mul_u32_u24 v6, 0x2400, v3
    v_add_u32 v201, v5, v6
    s_lshl_b32 s34, s13, 7
    s_lshl_b32 s35, s15, 17
    s_add_u32 s34, s34, s35
    s_mul_i32 s35, s14, 96
    s_lshl_b32 s36, s15, 2
    s_add_u32 s35, s35, s36
    s_mul_i32 s35, s35, 9216
    s_mul_i32 s68, s14, 1
    s_mov_b32 s69, 0
    s_mov_b32 s70, 0
    s_mov_b32 s74, s34
    s_mov_b32 s75, s35
    s_lshl_b32 s77, s68, 19
    s_add_u32 s34, s34, s77
    s_lshl_b32 s77, s68, 8
    s_add_u32 s35, s35, s77
    s_lshl_b32 s36, s15, 12
    s_lshl_b32 s37, s15, 10
    s_add_u32 s37, s37, 0x4000
    v_lshrrev_b32 v5, 5, v2
    v_lshrrev_b32 v6, 2, v4
    v_lshl_add_u32 v7, v5, 3, v6
    v_lshlrev_b32 v7, 7, v7
    v_bfe_u32 v8, v2, 4, 1
    v_lshlrev_b32 v8, 5, v8
    v_and_b32 v9, 3, v2
    v_lshl_add_u32 v8, v9, 3, v8
    v_add_u32 v7, v7, v8
    s_lshl_b32 s41, s15, 12
    v_add_u32 v7, s41, v7
    v_bfe_u32 v8, v2, 3, 1
    v_lshl_add_u32 v204, v8, 6, v7
    v_xor_b32 v205, 64, v204
    v_and_b32 v8, 31, v2
    s_lshl_b32 s41, s15, 2
    v_add_u32 v10, s41, v5
    v_xor_b32 v11, v10, v4
    v_lshlrev_b32 v11, 4, v11
    v_lshl_add_u32 v206, v8, 8, v11
    v_add_u32 v10, 2, v10
    v_xor_b32 v11, v10, v4
    v_lshlrev_b32 v11, 4, v11
    v_lshl_add_u32 v207, v8, 8, v11
    v_add_u32 v206, 0x4000, v206
    v_add_u32 v207, 0x4000, v207
    v_add_u32 v208, 40960, v204
    v_add_u32 v209, 40960, v205
    v_add_u32 v210, 40960, v206
    v_add_u32 v211, 40960, v207
    v_add_u32 v212, 81920, v204
    v_add_u32 v213, 81920, v205
    v_add_u32 v214, 81920, v206
    v_add_u32 v215, 81920, v207
    v_add_u32 v216, 122880, v204
    v_add_u32 v217, 122880, v205
    v_add_u32 v218, 122880, v206
    v_add_u32 v219, 122880, v207
    s_mul_i32 s41, s14, 96
    s_lshl_b32 s42, s15, 3
    s_add_u32 s41, s41, s42
    v_lshl_add_u32 v3, v5, 2, s41
    v_mov_b32 v222, v3
    s_lshl_b32 s42, s13, 6
    v_add_u32 v4, s42, v8
    v_mov_b32 v223, v4
    v_lshlrev_b32 v6, 12, v3
    v_lshl_add_u32 v6, v4, 1, v6
    v_lshlrev_b32 v7, 1, v4
    v_lshlrev_b32 v9, 2, v4
    s_mov_b32 s42, 0
    buffer_load_ushort v224, v6, s[48:51], s42 offen offset:0
    s_mov_b32 s42, 4096
    buffer_load_ushort v225, v6, s[48:51], s42 offen offset:0
    s_mov_b32 s42, 8192
    buffer_load_ushort v226, v6, s[48:51], s42 offen offset:0
    s_mov_b32 s42, 12288
    buffer_load_ushort v227, v6, s[48:51], s42 offen offset:0
    s_mov_b32 s42, 0
    buffer_load_ushort v228, v6, s[48:51], s42 offen offset:64
    s_mov_b32 s42, 4096
    buffer_load_ushort v229, v6, s[48:51], s42 offen offset:64
    s_mov_b32 s42, 8192
    buffer_load_ushort v230, v6, s[48:51], s42 offen offset:64
    s_mov_b32 s42, 12288
    buffer_load_ushort v231, v6, s[48:51], s42 offen offset:64
    s_mov_b32 s42, 131072
    buffer_load_ushort v232, v6, s[48:51], s42 offen offset:0
    s_mov_b32 s42, 135168
    buffer_load_ushort v233, v6, s[48:51], s42 offen offset:0
    s_mov_b32 s42, 139264
    buffer_load_ushort v234, v6, s[48:51], s42 offen offset:0
    s_mov_b32 s42, 143360
    buffer_load_ushort v235, v6, s[48:51], s42 offen offset:0
    s_mov_b32 s42, 131072
    buffer_load_ushort v236, v6, s[48:51], s42 offen offset:64
    s_mov_b32 s42, 135168
    buffer_load_ushort v237, v6, s[48:51], s42 offen offset:64
    s_mov_b32 s42, 139264
    buffer_load_ushort v238, v6, s[48:51], s42 offen offset:64
    s_mov_b32 s42, 143360
    buffer_load_ushort v239, v6, s[48:51], s42 offen offset:64
    s_mov_b32 s42, 262144
    buffer_load_ushort v240, v6, s[48:51], s42 offen offset:0
    s_mov_b32 s42, 266240
    buffer_load_ushort v241, v6, s[48:51], s42 offen offset:0
    s_mov_b32 s42, 270336
    buffer_load_ushort v242, v6, s[48:51], s42 offen offset:0
    s_mov_b32 s42, 274432
    buffer_load_ushort v243, v6, s[48:51], s42 offen offset:0
    s_mov_b32 s42, 262144
    buffer_load_ushort v244, v6, s[48:51], s42 offen offset:64
    s_mov_b32 s42, 266240
    buffer_load_ushort v245, v6, s[48:51], s42 offen offset:64
    s_mov_b32 s42, 270336
    buffer_load_ushort v246, v6, s[48:51], s42 offen offset:64
    s_mov_b32 s42, 274432
    buffer_load_ushort v247, v6, s[48:51], s42 offen offset:64
    buffer_load_ushort v248, v7, s[24:27], 0 offen
    buffer_load_ushort v249, v7, s[24:27], 0 offen offset:64
    buffer_load_dword v250, v9, s[52:55], 0 offen
    buffer_load_dword v251, v9, s[52:55], 0 offen offset:128
    v_mov_b32 v100, 0
    v_mov_b32 v101, 0
    v_mov_b32 v102, 0
    v_mov_b32 v103, 0
    v_mov_b32 v104, 0
    v_mov_b32 v105, 0
    v_mov_b32 v106, 0
    v_mov_b32 v107, 0
    v_mov_b32 v108, 0
    v_mov_b32 v109, 0
    v_mov_b32 v110, 0
    v_mov_b32 v111, 0
    v_mov_b32 v112, 0
    v_mov_b32 v113, 0
    v_mov_b32 v114, 0
    v_mov_b32 v115, 0
    v_mov_b32 v116, 0
    v_mov_b32 v117, 0
    v_mov_b32 v118, 0
    v_mov_b32 v119, 0
    v_mov_b32 v120, 0
    v_mov_b32 v121, 0
    v_mov_b32 v122, 0
    v_mov_b32 v123, 0
    v_mov_b32 v124, 0
    v_mov_b32 v125, 0
    v_mov_b32 v126, 0
    v_mov_b32 v127, 0
    v_mov_b32 v128, 0
    v_mov_b32 v129, 0
    v_mov_b32 v130, 0
    v_mov_b32 v131, 0
    v_mov_b32 v132, 0
    v_mov_b32 v133, 0
    v_mov_b32 v134, 0
    v_mov_b32 v135, 0
    v_mov_b32 v136, 0
    v_mov_b32 v137, 0
    v_mov_b32 v138, 0
    v_mov_b32 v139, 0
    v_mov_b32 v140, 0
    v_mov_b32 v141, 0
    v_mov_b32 v142, 0
    v_mov_b32 v143, 0
    v_mov_b32 v144, 0
    v_mov_b32 v145, 0
    v_mov_b32 v146, 0
    v_mov_b32 v147, 0
    v_mov_b32 v148, 0
    v_mov_b32 v149, 0
    v_mov_b32 v150, 0
    v_mov_b32 v151, 0
    v_mov_b32 v152, 0
    v_mov_b32 v153, 0
    v_mov_b32 v154, 0
    v_mov_b32 v155, 0
    v_mov_b32 v156, 0
    v_mov_b32 v157, 0
    v_mov_b32 v158, 0
    v_mov_b32 v159, 0
    v_mov_b32 v160, 0
    v_mov_b32 v161, 0
    v_mov_b32 v162, 0
    v_mov_b32 v163, 0
    v_mov_b32 v164, 0
    v_mov_b32 v165, 0
    v_mov_b32 v166, 0
    v_mov_b32 v167, 0
    v_mov_b32 v168, 0
    v_mov_b32 v169, 0
    v_mov_b32 v170, 0
    v_mov_b32 v171, 0
    v_mov_b32 v172, 0
    v_mov_b32 v173, 0
    v_mov_b32 v174, 0
    v_mov_b32 v175, 0
    v_mov_b32 v176, 0
    v_mov_b32 v177, 0
    v_mov_b32 v178, 0
    v_mov_b32 v179, 0
    v_mov_b32 v180, 0
    v_mov_b32 v181, 0
    v_mov_b32 v182, 0
    v_mov_b32 v183, 0
    v_mov_b32 v184, 0
    v_mov_b32 v185, 0
    v_mov_b32 v186, 0
    v_mov_b32 v187, 0
    v_mov_b32 v188, 0
    v_mov_b32 v189, 0
    v_mov_b32 v190, 0
    v_mov_b32 v191, 0
    v_mov_b32 v192, 0
    v_mov_b32 v193, 0
    v_mov_b32 v194, 0
    v_mov_b32 v195, 0
    s_add_u32 m0, s36, 0
    s_add_u32 s42, s34, 0
    buffer_load_dwordx4 v200, s[16:19], s42 offen lds
    s_add_u32 m0, s36, 1024
    s_add_u32 s42, s34, 32768
    buffer_load_dwordx4 v200, s[16:19], s42 offen lds
    s_add_u32 m0, s36, 2048
    s_add_u32 s42, s34, 65536
    buffer_load_dwordx4 v200, s[16:19], s42 offen lds
    s_add_u32 m0, s36, 3072
    s_add_u32 s42, s34, 98304
    buffer_load_dwordx4 v200, s[16:19], s42 offen lds
    s_add_u32 m0, s37, 0
    s_add_u32 s42, s35, 0
    buffer_load_dwordx4 v201, s[20:23], s42 offen lds
    s_add_u32 m0, s37, 4096
    s_add_u32 s42, s35, 147456
    buffer_load_dwordx4 v201, s[20:23], s42 offen lds
    s_add_u32 m0, s37, 8192
    s_add_u32 s42, s35, 294912
    buffer_load_dwordx4 v201, s[20:23], s42 offen lds
    s_add_u32 m0, s37, 12288
    s_add_u32 s42, s35, 442368
    buffer_load_dwordx4 v201, s[20:23], s42 offen lds
    s_add_u32 m0, s37, 16384
    s_add_u32 s42, s35, 589824
    buffer_load_dwordx4 v201, s[20:23], s42 offen lds
    s_add_u32 m0, s37, 20480
    s_add_u32 s42, s35, 737280
    buffer_load_dwordx4 v201, s[20:23], s42 offen lds
    s_add_u32 s68, s68, 1
    s_cmp_eq_u32 s68, 6
    s_cselect_b32 s68, 0, s68
    s_add_u32 s69, s69, 1
    s_cmp_eq_u32 s69, 6
    s_cselect_b32 s69, 0, s69
    s_cselect_b32 s76, 6, 0
    s_add_u32 s70, s70, s76
    s_add_u32 s76, s70, s68
    s_lshl_b32 s77, s76, 19
    s_add_u32 s34, s74, s77
    s_lshl_b32 s77, s76, 8
    s_add_u32 s35, s75, s77
    s_add_u32 m0, s36, 40960
    s_add_u32 s42, s34, 0
    buffer_load_dwordx4 v200, s[16:19], s42 offen lds
    s_add_u32 m0, s36, 41984
    s_add_u32 s42, s34, 32768
    buffer_load_dwordx4 v200, s[16:19], s42 offen lds
    s_add_u32 m0, s36, 43008
    s_add_u32 s42, s34, 65536
    buffer_load_dwordx4 v200, s[16:19], s42 offen lds
    s_add_u32 m0, s36, 44032
    s_add_u32 s42, s34, 98304
    buffer_load_dwordx4 v200, s[16:19], s42 offen lds
    s_add_u32 m0, s37, 40960
    s_add_u32 s42, s35, 0
    buffer_load_dwordx4 v201, s[20:23], s42 offen lds
    s_add_u32 m0, s37, 45056
    s_add_u32 s42, s35, 147456
    buffer_load_dwordx4 v201, s[20:23], s42 offen lds
    s_add_u32 m0, s37, 49152
    s_add_u32 s42, s35, 294912
    buffer_load_dwordx4 v201, s[20:23], s42 offen lds
    s_add_u32 m0, s37, 53248
    s_add_u32 s42, s35, 442368
    buffer_load_dwordx4 v201, s[20:23], s42 offen lds
    s_add_u32 m0, s37, 57344
    s_add_u32 s42, s35, 589824
    buffer_load_dwordx4 v201, s[20:23], s42 offen lds
    s_add_u32 m0, s37, 61440
    s_add_u32 s42, s35, 737280
    buffer_load_dwordx4 v201, s[20:23], s42 offen lds
    s_add_u32 s68, s68, 1
    s_cmp_eq_u32 s68, 6
    s_cselect_b32 s68, 0, s68
    s_add_u32 s69, s69, 1
    s_cmp_eq_u32 s69, 6
    s_cselect_b32 s69, 0, s69
    s_cselect_b32 s76, 6, 0
    s_add_u32 s70, s70, s76
    s_add_u32 s76, s70, s68
    s_lshl_b32 s77, s76, 19
    s_add_u32 s34, s74, s77
    s_lshl_b32 s77, s76, 8
    s_add_u32 s35, s75, s77
    s_add_u32 m0, s36, 81920
    s_add_u32 s42, s34, 0
    buffer_load_dwordx4 v200, s[16:19], s42 offen lds
    s_add_u32 m0, s36, 82944
    s_add_u32 s42, s34, 32768
    buffer_load_dwordx4 v200, s[16:19], s42 offen lds
    s_add_u32 m0, s36, 83968
    s_add_u32 s42, s34, 65536
    buffer_load_dwordx4 v200, s[16:19], s42 offen lds
    s_add_u32 m0, s36, 84992
    s_add_u32 s42, s34, 98304
    buffer_load_dwordx4 v200, s[16:19], s42 offen lds
    s_add_u32 m0, s37, 81920
    s_add_u32 s42, s35, 0
    buffer_load_dwordx4 v201, s[20:23], s42 offen lds
    s_add_u32 m0, s37, 86016
    s_add_u32 s42, s35, 147456
    buffer_load_dwordx4 v201, s[20:23], s42 offen lds
    s_add_u32 m0, s37, 90112
    s_add_u32 s42, s35, 294912
    buffer_load_dwordx4 v201, s[20:23], s42 offen lds
    s_add_u32 m0, s37, 94208
    s_add_u32 s42, s35, 442368
    buffer_load_dwordx4 v201, s[20:23], s42 offen lds
    s_add_u32 m0, s37, 98304
    s_add_u32 s42, s35, 589824
    buffer_load_dwordx4 v201, s[20:23], s42 offen lds
    s_add_u32 m0, s37, 102400
    s_add_u32 s42, s35, 737280
    buffer_load_dwordx4 v201, s[20:23], s42 offen lds
    s_add_u32 s68, s68, 1
    s_cmp_eq_u32 s68, 6
    s_cselect_b32 s68, 0, s68
    s_add_u32 s69, s69, 1
    s_cmp_eq_u32 s69, 6
    s_cselect_b32 s69, 0, s69
    s_cselect_b32 s76, 6, 0
    s_add_u32 s70, s70, s76
    s_add_u32 s76, s70, s68
    s_lshl_b32 s77, s76, 19
    s_add_u32 s34, s74, s77
    s_lshl_b32 s77, s76, 8
    s_add_u32 s35, s75, s77
    s_waitcnt vmcnt(20)
    s_barrier
    ds_read_b64_tr_b16 v[10:11], v204 offset:0
    ds_read_b64_tr_b16 v[12:13], v204 offset:512
    ds_read_b64_tr_b16 v[14:15], v205 offset:0
    ds_read_b64_tr_b16 v[16:17], v205 offset:512
    ds_read_b128 v[18:21], v206 offset:0
    ds_read_b128 v[22:25], v206 offset:8192
    ds_read_b128 v[26:29], v206 offset:16384
    s_mov_b32 s40, 8
L_g2_loop:
    ds_read_b64_tr_b16 v[30:31], v204 offset:2048
    ds_read_b64_tr_b16 v[32:33], v204 offset:2560
    ds_read_b64_tr_b16 v[34:35], v205 offset:2048
    ds_read_b64_tr_b16 v[36:37], v205 offset:2560
    ds_read_b128 v[38:41], v207 offset:0
    ds_read_b128 v[42:45], v207 offset:8192
    ds_read_b128 v[46:49], v207 offset:16384
    s_waitcnt lgkmcnt(7)
    v_mfma_f32_32x32x16_bf16 v[100:115], v[18:21], v[10:13], v[100:115]
    v_mfma_f32_32x32x16_bf16 v[116:131], v[22:25], v[10:13], v[116:131]
    v_mfma_f32_32x32x16_bf16 v[132:147], v[26:29], v[10:13], v[132:147]
    v_mfma_f32_32x32x16_bf16 v[148:163], v[18:21], v[14:17], v[148:163]
    v_mfma_f32_32x32x16_bf16 v[164:179], v[22:25], v[14:17], v[164:179]
    v_mfma_f32_32x32x16_bf16 v[180:195], v[26:29], v[14:17], v[180:195]
    s_waitcnt vmcnt(10)
    s_barrier
    ds_read_b64_tr_b16 v[10:11], v208 offset:0
    ds_read_b64_tr_b16 v[12:13], v208 offset:512
    ds_read_b64_tr_b16 v[14:15], v209 offset:0
    ds_read_b64_tr_b16 v[16:17], v209 offset:512
    ds_read_b128 v[18:21], v210 offset:0
    ds_read_b128 v[22:25], v210 offset:8192
    ds_read_b128 v[26:29], v210 offset:16384
    s_waitcnt lgkmcnt(7)
    v_mfma_f32_32x32x16_bf16 v[100:115], v[38:41], v[30:33], v[100:115]
    s_add_u32 m0, s36, 122880
    s_add_u32 s42, s34, 0
    buffer_load_dwordx4 v200, s[16:19], s42 offen lds
    s_add_u32 m0, s36, 123904
    s_add_u32 s42, s34, 32768
    buffer_load_dwordx4 v200, s[16:19], s42 offen lds
    v_mfma_f32_32x32x16_bf16 v[116:131], v[42:45], v[30:33], v[116:131]
    s_add_u32 m0, s36, 124928
    s_add_u32 s42, s34, 65536
    buffer_load_dwordx4 v200, s[16:19], s42 offen lds
    s_add_u32 m0, s36, 125952
    s_add_u32 s42, s34, 98304
    buffer_load_dwordx4 v200, s[16:19], s42 offen lds
    v_mfma_f32_32x32x16_bf16 v[132:147], v[46:49], v[30:33], v[132:147]
    s_add_u32 m0, s37, 122880
    s_add_u32 s42, s35, 0
    buffer_load_dwordx4 v201, s[20:23], s42 offen lds
    s_add_u32 m0, s37, 126976
    s_add_u32 s42, s35, 147456
    buffer_load_dwordx4 v201, s[20:23], s42 offen lds
    v_mfma_f32_32x32x16_bf16 v[148:163], v[38:41], v[34:37], v[148:163]
    s_add_u32 m0, s37, 131072
    s_add_u32 s42, s35, 294912
    buffer_load_dwordx4 v201, s[20:23], s42 offen lds
    s_add_u32 m0, s37, 135168
    s_add_u32 s42, s35, 442368
    buffer_load_dwordx4 v201, s[20:23], s42 offen lds
    v_mfma_f32_32x32x16_bf16 v[164:179], v[42:45], v[34:37], v[164:179]
    s_add_u32 m0, s37, 139264
    s_add_u32 s42, s35, 589824
    buffer_load_dwordx4 v201, s[20:23], s42 offen lds
    s_add_u32 m0, s37, 143360
    s_add_u32 s42, s35, 737280
    buffer_load_dwordx4 v201, s[20:23], s42 offen lds
    v_mfma_f32_32x32x16_bf16 v[180:195], v[46:49], v[34:37], v[180:195]
    s_add_u32 s68, s68, 1
    s_cmp_eq_u32 s68, 6
    s_cselect_b32 s68, 0, s68
    s_add_u32 s69, s69, 1
    s_cmp_eq_u32 s69, 6
    s_cselect_b32 s69, 0, s69
    s_cselect_b32 s76, 6, 0
    s_add_u32 s70, s70, s76
    s_add_u32 s76, s70, s68
    s_lshl_b32 s77, s76, 19
    s_add_u32 s34, s74, s77
    s_lshl_b32 s77, s76, 8
    s_add_u32 s35, s75, s77
    ds_read_b64_tr_b16 v[30:31], v208 offset:2048
    ds_read_b64_tr_b16 v[32:33], v208 offset:2560
    ds_read_b64_tr_b16 v[34:35], v209 offset:2048
    ds_read_b64_tr_b16 v[36:37], v209 offset:2560
    ds_read_b128 v[38:41], v211 offset:0
    ds_read_b128 v[42:45], v211 offset:8192
    ds_read_b128 v[46:49], v211 offset:16384
    s_waitcnt lgkmcnt(7)
    v_mfma_f32_32x32x16_bf16 v[100:115], v[18:21], v[10:13], v[100:115]
    v_mfma_f32_32x32x16_bf16 v[116:131], v[22:25], v[10:13], v[116:131]
    v_mfma_f32_32x32x16_bf16 v[132:147], v[26:29], v[10:13], v[132:147]
    v_mfma_f32_32x32x16_bf16 v[148:163], v[18:21], v[14:17], v[148:163]
    v_mfma_f32_32x32x16_bf16 v[164:179], v[22:25], v[14:17], v[164:179]
    v_mfma_f32_32x32x16_bf16 v[180:195], v[26:29], v[14:17], v[180:195]
    s_waitcnt vmcnt(10)
    s_barrier
    ds_read_b64_tr_b16 v[10:11], v212 offset:0
    ds_read_b64_tr_b16 v[12:13], v212 offset:512
    ds_read_b64_tr_b16 v[14:15], v213 offset:0
    ds_read_b64_tr_b16 v[16:17], v213 offset:512
    ds_read_b128 v[18:21], v214 offset:0
    ds_read_b128 v[22:25], v214 offset:8192
    ds_read_b128 v[26:29], v214 offset:16384
    s_waitcnt lgkmcnt(7)
    v_mfma_f32_32x32x16_bf16 v[100:115], v[38:41], v[30:33], v[100:115]
    s_add_u32 m0, s36, 0
    s_add_u32 s42, s34, 0
    buffer_load_dwordx4 v200, s[16:19], s42 offen lds
    s_add_u32 m0, s36, 1024
    s_add_u32 s42, s34, 32768
    buffer_load_dwordx4 v200, s[16:19], s42 offen lds
    v_mfma_f32_32x32x16_bf16 v[116:131], v[42:45], v[30:33], v[116:131]
    s_add_u32 m0, s36, 2048
    s_add_u32 s42, s34, 65536
    buffer_load_dwordx4 v200, s[16:19], s42 offen lds
    s_add_u32 m0, s36, 3072
    s_add_u32 s42, s34, 98304
    buffer_load_dwordx4 v200, s[16:19], s42 offen lds
    v_mfma_f32_32x32x16_bf16 v[132:147], v[46:49], v[30:33], v[132:147]
    s_add_u32 m0, s37, 0
    s_add_u32 s42, s35, 0
    buffer_load_dwordx4 v201, s[20:23], s42 offen lds
    s_add_u32 m0, s37, 4096
    s_add_u32 s42, s35, 147456
    buffer_load_dwordx4 v201, s[20:23], s42 offen lds
    v_mfma_f32_32x32x16_bf16 v[148:163], v[38:41], v[34:37], v[148:163]
    s_add_u32 m0, s37, 8192
    s_add_u32 s42, s35, 294912
    buffer_load_dwordx4 v201, s[20:23], s42 offen lds
    s_add_u32 m0, s37, 12288
    s_add_u32 s42, s35, 442368
    buffer_load_dwordx4 v201, s[20:23], s42 offen lds
    v_mfma_f32_32x32x16_bf16 v[164:179], v[42:45], v[34:37], v[164:179]
    s_add_u32 m0, s37, 16384
    s_add_u32 s42, s35, 589824
    buffer_load_dwordx4 v201, s[20:23], s42 offen lds
    s_add_u32 m0, s37, 20480
    s_add_u32 s42, s35, 737280
    buffer_load_dwordx4 v201, s[20:23], s42 offen lds
    v_mfma_f32_32x32x16_bf16 v[180:195], v[46:49], v[34:37], v[180:195]
    s_add_u32 s68, s68, 1
    s_cmp_eq_u32 s68, 6
    s_cselect_b32 s68, 0, s68
    s_add_u32 s69, s69, 1
    s_cmp_eq_u32 s69, 6
    s_cselect_b32 s69, 0, s69
    s_cselect_b32 s76, 6, 0
    s_add_u32 s70, s70, s76
    s_add_u32 s76, s70, s68
    s_lshl_b32 s77, s76, 19
    s_add_u32 s34, s74, s77
    s_lshl_b32 s77, s76, 8
    s_add_u32 s35, s75, s77
    ds_read_b64_tr_b16 v[30:31], v212 offset:2048
    ds_read_b64_tr_b16 v[32:33], v212 offset:2560
    ds_read_b64_tr_b16 v[34:35], v213 offset:2048
    ds_read_b64_tr_b16 v[36:37], v213 offset:2560
    ds_read_b128 v[38:41], v215 offset:0
    ds_read_b128 v[42:45], v215 offset:8192
    ds_read_b128 v[46:49], v215 offset:16384
    s_waitcnt lgkmcnt(7)
    v_mfma_f32_32x32x16_bf16 v[100:115], v[18:21], v[10:13], v[100:115]
    v_mfma_f32_32x32x16_bf16 v[116:131], v[22:25], v[10:13], v[116:131]
    v_mfma_f32_32x32x16_bf16 v[132:147], v[26:29], v[10:13], v[132:147]
    v_mfma_f32_32x32x16_bf16 v[148:163], v[18:21], v[14:17], v[148:163]
    v_mfma_f32_32x32x16_bf16 v[164:179], v[22:25], v[14:17], v[164:179]
    v_mfma_f32_32x32x16_bf16 v[180:195], v[26:29], v[14:17], v[180:195]
    s_waitcnt vmcnt(10)
    s_barrier
    ds_read_b64_tr_b16 v[10:11], v216 offset:0
    ds_read_b64_tr_b16 v[12:13], v216 offset:512
    ds_read_b64_tr_b16 v[14:15], v217 offset:0
    ds_read_b64_tr_b16 v[16:17], v217 offset:512
    ds_read_b128 v[18:21], v218 offset:0
    ds_read_b128 v[22:25], v218 offset:8192
    ds_read_b128 v[26:29], v218 offset:16384
    s_waitcnt lgkmcnt(7)
    v_mfma_f32_32x32x16_bf16 v[100:115], v[38:41], v[30:33], v[100:115]
    s_add_u32 m0, s36, 40960
    s_add_u32 s42, s34, 0
    buffer_load_dwordx4 v200, s[16:19], s42 offen lds
    s_add_u32 m0, s36, 41984
    s_add_u32 s42, s34, 32768
    buffer_load_dwordx4 v200, s[16:19], s42 offen lds
    v_mfma_f32_32x32x16_bf16 v[116:131], v[42:45], v[30:33], v[116:131]
    s_add_u32 m0, s36, 43008
    s_add_u32 s42, s34, 65536
    buffer_load_dwordx4 v200, s[16:19], s42 offen lds
    s_add_u32 m0, s36, 44032
    s_add_u32 s42, s34, 98304
    buffer_load_dwordx4 v200, s[16:19], s42 offen lds
    v_mfma_f32_32x32x16_bf16 v[132:147], v[46:49], v[30:33], v[132:147]
    s_add_u32 m0, s37, 40960
    s_add_u32 s42, s35, 0
    buffer_load_dwordx4 v201, s[20:23], s42 offen lds
    s_add_u32 m0, s37, 45056
    s_add_u32 s42, s35, 147456
    buffer_load_dwordx4 v201, s[20:23], s42 offen lds
    v_mfma_f32_32x32x16_bf16 v[148:163], v[38:41], v[34:37], v[148:163]
    s_add_u32 m0, s37, 49152
    s_add_u32 s42, s35, 294912
    buffer_load_dwordx4 v201, s[20:23], s42 offen lds
    s_add_u32 m0, s37, 53248
    s_add_u32 s42, s35, 442368
    buffer_load_dwordx4 v201, s[20:23], s42 offen lds
    v_mfma_f32_32x32x16_bf16 v[164:179], v[42:45], v[34:37], v[164:179]
    s_add_u32 m0, s37, 57344
    s_add_u32 s42, s35, 589824
    buffer_load_dwordx4 v201, s[20:23], s42 offen lds
    s_add_u32 m0, s37, 61440
    s_add_u32 s42, s35, 737280
    buffer_load_dwordx4 v201, s[20:23], s42 offen lds
    v_mfma_f32_32x32x16_bf16 v[180:195], v[46:49], v[34:37], v[180:195]
    s_add_u32 s68, s68, 1
    s_cmp_eq_u32 s68, 6
    s_cselect_b32 s68, 0, s68
    s_add_u32 s69, s69, 1
    s_cmp_eq_u32 s69, 6
    s_cselect_b32 s69, 0, s69
    s_cselect_b32 s76, 6, 0
    s_add_u32 s70, s70, s76
    s_add_u32 s76, s70, s68
    s_lshl_b32 s77, s76, 19
    s_add_u32 s34, s74, s77
    s_lshl_b32 s77, s76, 8
    s_add_u32 s35, s75, s77
    ds_read_b64_tr_b16 v[30:31], v216 offset:2048
    ds_read_b64_tr_b16 v[32:33], v216 offset:2560
    ds_read_b64_tr_b16 v[34:35], v217 offset:2048
    ds_read_b64_tr_b16 v[36:37], v217 offset:2560
    ds_read_b128 v[38:41], v219 offset:0
    ds_read_b128 v[42:45], v219 offset:8192
    ds_read_b128 v[46:49], v219 offset:16384
    s_waitcnt lgkmcnt(7)
    v_mfma_f32_32x32x16_bf16 v[100:115], v[18:21], v[10:13], v[100:115]
    v_mfma_f32_32x32x16_bf16 v[116:131], v[22:25], v[10:13], v[116:131]
    v_mfma_f32_32x32x16_bf16 v[132:147], v[26:29], v[10:13], v[132:147]
    v_mfma_f32_32x32x16_bf16 v[148:163], v[18:21], v[14:17], v[148:163]
    v_mfma_f32_32x32x16_bf16 v[164:179], v[22:25], v[14:17], v[164:179]
    v_mfma_f32_32x32x16_bf16 v[180:195], v[26:29], v[14:17], v[180:195]
    s_waitcnt vmcnt(10)
    s_barrier
    ds_read_b64_tr_b16 v[10:11], v204 offset:0
    ds_read_b64_tr_b16 v[12:13], v204 offset:512
    ds_read_b64_tr_b16 v[14:15], v205 offset:0
    ds_read_b64_tr_b16 v[16:17], v205 offset:512
    ds_read_b128 v[18:21], v206 offset:0
    ds_read_b128 v[22:25], v206 offset:8192
    ds_read_b128 v[26:29], v206 offset:16384
    s_waitcnt lgkmcnt(7)
    v_mfma_f32_32x32x16_bf16 v[100:115], v[38:41], v[30:33], v[100:115]
    s_add_u32 m0, s36, 81920
    s_add_u32 s42, s34, 0
    buffer_load_dwordx4 v200, s[16:19], s42 offen lds
    s_add_u32 m0, s36, 82944
    s_add_u32 s42, s34, 32768
    buffer_load_dwordx4 v200, s[16:19], s42 offen lds
    v_mfma_f32_32x32x16_bf16 v[116:131], v[42:45], v[30:33], v[116:131]
    s_add_u32 m0, s36, 83968
    s_add_u32 s42, s34, 65536
    buffer_load_dwordx4 v200, s[16:19], s42 offen lds
    s_add_u32 m0, s36, 84992
    s_add_u32 s42, s34, 98304
    buffer_load_dwordx4 v200, s[16:19], s42 offen lds
    v_mfma_f32_32x32x16_bf16 v[132:147], v[46:49], v[30:33], v[132:147]
    s_add_u32 m0, s37, 81920
    s_add_u32 s42, s35, 0
    buffer_load_dwordx4 v201, s[20:23], s42 offen lds
    s_add_u32 m0, s37, 86016
    s_add_u32 s42, s35, 147456
    buffer_load_dwordx4 v201, s[20:23], s42 offen lds
    v_mfma_f32_32x32x16_bf16 v[148:163], v[38:41], v[34:37], v[148:163]
    s_add_u32 m0, s37, 90112
    s_add_u32 s42, s35, 294912
    buffer_load_dwordx4 v201, s[20:23], s42 offen lds
    s_add_u32 m0, s37, 94208
    s_add_u32 s42, s35, 442368
    buffer_load_dwordx4 v201, s[20:23], s42 offen lds
    v_mfma_f32_32x32x16_bf16 v[164:179], v[42:45], v[34:37], v[164:179]
    s_add_u32 m0, s37, 98304
    s_add_u32 s42, s35, 589824
    buffer_load_dwordx4 v201, s[20:23], s42 offen lds
    s_add_u32 m0, s37, 102400
    s_add_u32 s42, s35, 737280
    buffer_load_dwordx4 v201, s[20:23], s42 offen lds
    v_mfma_f32_32x32x16_bf16 v[180:195], v[46:49], v[34:37], v[180:195]
    s_add_u32 s68, s68, 1
    s_cmp_eq_u32 s68, 6
    s_cselect_b32 s68, 0, s68
    s_add_u32 s69, s69, 1
    s_cmp_eq_u32 s69, 6
    s_cselect_b32 s69, 0, s69
    s_cselect_b32 s76, 6, 0
    s_add_u32 s70, s70, s76
    s_add_u32 s76, s70, s68
    s_lshl_b32 s77, s76, 19
    s_add_u32 s34, s74, s77
    s_lshl_b32 s77, s76, 8
    s_add_u32 s35, s75, s77
    s_sub_u32 s40, s40, 1
    s_cmp_lg_u32 s40, 0
    s_cbranch_scc1 L_g2_loop
    ds_read_b64_tr_b16 v[30:31], v204 offset:2048
    ds_read_b64_tr_b16 v[32:33], v204 offset:2560
    ds_read_b64_tr_b16 v[34:35], v205 offset:2048
    ds_read_b64_tr_b16 v[36:37], v205 offset:2560
    ds_read_b128 v[38:41], v207 offset:0
    ds_read_b128 v[42:45], v207 offset:8192
    ds_read_b128 v[46:49], v207 offset:16384
    s_waitcnt lgkmcnt(7)
    v_mfma_f32_32x32x16_bf16 v[100:115], v[18:21], v[10:13], v[100:115]
    v_mfma_f32_32x32x16_bf16 v[116:131], v[22:25], v[10:13], v[116:131]
    v_mfma_f32_32x32x16_bf16 v[132:147], v[26:29], v[10:13], v[132:147]
    v_mfma_f32_32x32x16_bf16 v[148:163], v[18:21], v[14:17], v[148:163]
    v_mfma_f32_32x32x16_bf16 v[164:179], v[22:25], v[14:17], v[164:179]
    v_mfma_f32_32x32x16_bf16 v[180:195], v[26:29], v[14:17], v[180:195]
    s_waitcnt vmcnt(10)
    s_barrier
    ds_read_b64_tr_b16 v[10:11], v208 offset:0
    ds_read_b64_tr_b16 v[12:13], v208 offset:512
    ds_read_b64_tr_b16 v[14:15], v209 offset:0
    ds_read_b64_tr_b16 v[16:17], v209 offset:512
    ds_read_b128 v[18:21], v210 offset:0
    ds_read_b128 v[22:25], v210 offset:8192
    ds_read_b128 v[26:29], v210 offset:16384
    s_waitcnt lgkmcnt(7)
    v_mfma_f32_32x32x16_bf16 v[100:115], v[38:41], v[30:33], v[100:115]
    s_add_u32 m0, s36, 122880
    s_add_u32 s42, s34, 0
    buffer_load_dwordx4 v200, s[16:19], s42 offen lds
    s_add_u32 m0, s36, 123904
    s_add_u32 s42, s34, 32768
    buffer_load_dwordx4 v200, s[16:19], s42 offen lds
    v_mfma_f32_32x32x16_bf16 v[116:131], v[42:45], v[30:33], v[116:131]
    s_add_u32 m0, s36, 124928
    s_add_u32 s42, s34, 65536
    buffer_load_dwordx4 v200, s[16:19], s42 offen lds
    s_add_u32 m0, s36, 125952
    s_add_u32 s42, s34, 98304
    buffer_load_dwordx4 v200, s[16:19], s42 offen lds
    v_mfma_f32_32x32x16_bf16 v[132:147], v[46:49], v[30:33], v[132:147]
    s_add_u32 m0, s37, 122880
    s_add_u32 s42, s35, 0
    buffer_load_dwordx4 v201, s[20:23], s42 offen lds
    s_add_u32 m0, s37, 126976
    s_add_u32 s42, s35, 147456
    buffer_load_dwordx4 v201, s[20:23], s42 offen lds
    v_mfma_f32_32x32x16_bf16 v[148:163], v[38:41], v[34:37], v[148:163]
    s_add_u32 m0, s37, 131072
    s_add_u32 s42, s35, 294912
    buffer_load_dwordx4 v201, s[20:23], s42 offen lds
    s_add_u32 m0, s37, 135168
    s_add_u32 s42, s35, 442368
    buffer_load_dwordx4 v201, s[20:23], s42 offen lds
    v_mfma_f32_32x32x16_bf16 v[164:179], v[42:45], v[34:37], v[164:179]
    s_add_u32 m0, s37, 139264
    s_add_u32 s42, s35, 589824
    buffer_load_dwordx4 v201, s[20:23], s42 offen lds
    s_add_u32 m0, s37, 143360
    s_add_u32 s42, s35, 737280
    buffer_load_dwordx4 v201, s[20:23], s42 offen lds
    v_mfma_f32_32x32x16_bf16 v[180:195], v[46:49], v[34:37], v[180:195]
    s_add_u32 s68, s68, 1
    s_cmp_eq_u32 s68, 6
    s_cselect_b32 s68, 0, s68
    s_add_u32 s69, s69, 1
    s_cmp_eq_u32 s69, 6
    s_cselect_b32 s69, 0, s69
    s_cselect_b32 s76, 6, 0
    s_add_u32 s70, s70, s76
    s_add_u32 s76, s70, s68
    s_lshl_b32 s77, s76, 19
    s_add_u32 s34, s74, s77
    s_lshl_b32 s77, s76, 8
    s_add_u32 s35, s75, s77
    ds_read_b64_tr_b16 v[30:31], v208 offset:2048
    ds_read_b64_tr_b16 v[32:33], v208 offset:2560
    ds_read_b64_tr_b16 v[34:35], v209 offset:2048
    ds_read_b64_tr_b16 v[36:37], v209 offset:2560
    ds_read_b128 v[38:41], v211 offset:0
    ds_read_b128 v[42:45], v211 offset:8192
    ds_read_b128 v[46:49], v211 offset:16384
    s_waitcnt lgkmcnt(7)
    v_mfma_f32_32x32x16_bf16 v[100:115], v[18:21], v[10:13], v[100:115]
    v_mfma_f32_32x32x16_bf16 v[116:131], v[22:25], v[10:13], v[116:131]
    v_mfma_f32_32x32x16_bf16 v[132:147], v[26:29], v[10:13], v[132:147]
    v_mfma_f32_32x32x16_bf16 v[148:163], v[18:21], v[14:17], v[148:163]
    v_mfma_f32_32x32x16_bf16 v[164:179], v[22:25], v[14:17], v[164:179]
    v_mfma_f32_32x32x16_bf16 v[180:195], v[26:29], v[14:17], v[180:195]
    s_waitcnt vmcnt(10)
    s_barrier
    ds_read_b64_tr_b16 v[10:11], v212 offset:0
    ds_read_b64_tr_b16 v[12:13], v212 offset:512
    ds_read_b64_tr_b16 v[14:15], v213 offset:0
    ds_read_b64_tr_b16 v[16:17], v213 offset:512
    ds_read_b128 v[18:21], v214 offset:0
    ds_read_b128 v[22:25], v214 offset:8192
    ds_read_b128 v[26:29], v214 offset:16384
    s_waitcnt lgkmcnt(7)
    v_mfma_f32_32x32x16_bf16 v[100:115], v[38:41], v[30:33], v[100:115]
    v_mfma_f32_32x32x16_bf16 v[116:131], v[42:45], v[30:33], v[116:131]
    v_mfma_f32_32x32x16_bf16 v[132:147], v[46:49], v[30:33], v[132:147]
    v_mfma_f32_32x32x16_bf16 v[148:163], v[38:41], v[34:37], v[148:163]
    v_mfma_f32_32x32x16_bf16 v[164:179], v[42:45], v[34:37], v[164:179]
    v_mfma_f32_32x32x16_bf16 v[180:195], v[46:49], v[34:37], v[180:195]
    ds_read_b64_tr_b16 v[30:31], v212 offset:2048
    ds_read_b64_tr_b16 v[32:33], v212 offset:2560
    ds_read_b64_tr_b16 v[34:35], v213 offset:2048
    ds_read_b64_tr_b16 v[36:37], v213 offset:2560
    ds_read_b128 v[38:41], v215 offset:0
    ds_read_b128 v[42:45], v215 offset:8192
    ds_read_b128 v[46:49], v215 offset:16384
    s_waitcnt lgkmcnt(7)
    v_mfma_f32_32x32x16_bf16 v[100:115], v[18:21], v[10:13], v[100:115]
    v_mfma_f32_32x32x16_bf16 v[116:131], v[22:25], v[10:13], v[116:131]
    v_mfma_f32_32x32x16_bf16 v[132:147], v[26:29], v[10:13], v[132:147]
    v_mfma_f32_32x32x16_bf16 v[148:163], v[18:21], v[14:17], v[148:163]
    v_mfma_f32_32x32x16_bf16 v[164:179], v[22:25], v[14:17], v[164:179]
    v_mfma_f32_32x32x16_bf16 v[180:195], v[26:29], v[14:17], v[180:195]
    s_waitcnt vmcnt(0)
    s_barrier
    ds_read_b64_tr_b16 v[10:11], v216 offset:0
    ds_read_b64_tr_b16 v[12:13], v216 offset:512
    ds_read_b64_tr_b16 v[14:15], v217 offset:0
    ds_read_b64_tr_b16 v[16:17], v217 offset:512
    ds_read_b128 v[18:21], v218 offset:0
    ds_read_b128 v[22:25], v218 offset:8192
    ds_read_b128 v[26:29], v218 offset:16384
    s_waitcnt lgkmcnt(7)
    v_mfma_f32_32x32x16_bf16 v[100:115], v[38:41], v[30:33], v[100:115]
    v_mfma_f32_32x32x16_bf16 v[116:131], v[42:45], v[30:33], v[116:131]
    v_mfma_f32_32x32x16_bf16 v[132:147], v[46:49], v[30:33], v[132:147]
    v_mfma_f32_32x32x16_bf16 v[148:163], v[38:41], v[34:37], v[148:163]
    v_mfma_f32_32x32x16_bf16 v[164:179], v[42:45], v[34:37], v[164:179]
    v_mfma_f32_32x32x16_bf16 v[180:195], v[46:49], v[34:37], v[180:195]
    ds_read_b64_tr_b16 v[30:31], v216 offset:2048
    ds_read_b64_tr_b16 v[32:33], v216 offset:2560
    ds_read_b64_tr_b16 v[34:35], v217 offset:2048
    ds_read_b64_tr_b16 v[36:37], v217 offset:2560
    ds_read_b128 v[38:41], v219 offset:0
    ds_read_b128 v[42:45], v219 offset:8192
    ds_read_b128 v[46:49], v219 offset:16384
    s_waitcnt lgkmcnt(7)
    v_mfma_f32_32x32x16_bf16 v[100:115], v[18:21], v[10:13], v[100:115]
    v_mfma_f32_32x32x16_bf16 v[116:131], v[22:25], v[10:13], v[116:131]
    v_mfma_f32_32x32x16_bf16 v[132:147], v[26:29], v[10:13], v[132:147]
    v_mfma_f32_32x32x16_bf16 v[148:163], v[18:21], v[14:17], v[148:163]
    v_mfma_f32_32x32x16_bf16 v[164:179], v[22:25], v[14:17], v[164:179]
    v_mfma_f32_32x32x16_bf16 v[180:195], v[26:29], v[14:17], v[180:195]
    s_waitcnt lgkmcnt(0)
    v_mfma_f32_32x32x16_bf16 v[100:115], v[38:41], v[30:33], v[100:115]
    v_mfma_f32_32x32x16_bf16 v[116:131], v[42:45], v[30:33], v[116:131]
    v_mfma_f32_32x32x16_bf16 v[132:147], v[46:49], v[30:33], v[132:147]
    v_mfma_f32_32x32x16_bf16 v[148:163], v[38:41], v[34:37], v[148:163]
    v_mfma_f32_32x32x16_bf16 v[164:179], v[42:45], v[34:37], v[164:179]
    v_mfma_f32_32x32x16_bf16 v[180:195], v[46:49], v[34:37], v[180:195]
    s_nop 15
    s_barrier
    v_lshlrev_b32 v3, 4, v2
    s_mul_i32 s41, s15, 6144
    v_add_u32 v3, s41, v3
    v_lshlrev_b32 v4, 4, v2
    s_mul_i32 s41, s15, 24576
    v_add_u32 v4, s41, v4
    v_add_u32 v5, 0xc000, v3
    ds_write_b128 v3, v[100:103] offset:0
    ds_write_b128 v3, v[116:119] offset:1024
    ds_write_b128 v3, v[132:135] offset:2048
    ds_write_b128 v3, v[148:151] offset:3072
    ds_write_b128 v3, v[164:167] offset:4096
    ds_write_b128 v3, v[180:183] offset:5120
    ds_write_b128 v3, v[104:107] offset:24576
    ds_write_b128 v3, v[120:123] offset:25600
    ds_write_b128 v3, v[136:139] offset:26624
    ds_write_b128 v3, v[152:155] offset:27648
    ds_write_b128 v3, v[168:171] offset:28672
    ds_write_b128 v3, v[184:187] offset:29696
    ds_write_b128 v5, v[108:111] offset:0
    ds_write_b128 v5, v[124:127] offset:1024
    ds_write_b128 v5, v[140:143] offset:2048
    ds_write_b128 v5, v[156:159] offset:3072
    ds_write_b128 v5, v[172:175] offset:4096
    ds_write_b128 v5, v[188:191] offset:5120
    ds_write_b128 v5, v[112:115] offset:24576
    ds_write_b128 v5, v[128:131] offset:25600
    ds_write_b128 v5, v[144:147] offset:26624
    ds_write_b128 v5, v[160:163] offset:27648
    ds_write_b128 v5, v[176:179] offset:28672
    ds_write_b128 v5, v[192:195] offset:29696
    s_waitcnt lgkmcnt(0)
    s_barrier
    ds_read_b128 v[10:13], v4 offset:0
    ds_read_b128 v[14:17], v4 offset:1024
    ds_read_b128 v[18:21], v4 offset:2048
    ds_read_b128 v[22:25], v4 offset:3072
    ds_read_b128 v[26:29], v4 offset:4096
    ds_read_b128 v[30:33], v4 offset:5120
    ds_read_b128 v[34:37], v4 offset:6144
    ds_read_b128 v[38:41], v4 offset:7168
    ds_read_b128 v[42:45], v4 offset:8192
    ds_read_b128 v[46:49], v4 offset:9216
    ds_read_b128 v[50:53], v4 offset:10240
    ds_read_b128 v[54:57], v4 offset:11264
    ds_read_b128 v[58:61], v4 offset:12288
    ds_read_b128 v[62:65], v4 offset:13312
    ds_read_b128 v[66:69], v4 offset:14336
    ds_read_b128 v[70:73], v4 offset:15360
    ds_read_b128 v[74:77], v4 offset:16384
    ds_read_b128 v[78:81], v4 offset:17408
    ds_read_b128 v[82:85], v4 offset:18432
    ds_read_b128 v[86:89], v4 offset:19456
    ds_read_b128 v[90:93], v4 offset:20480
    ds_read_b128 v[94:97], v4 offset:21504
    ds_read_b128 v[98:101], v4 offset:22528
    ds_read_b128 v[102:105], v4 offset:23552
    s_waitcnt vmcnt(0) lgkmcnt(0)
    v_add_f32 v10, v10, v34
    v_add_f32 v58, v58, v82
    v_add_f32 v11, v11, v35
    v_add_f32 v59, v59, v83
    v_add_f32 v12, v12, v36
    v_add_f32 v60, v60, v84
    v_add_f32 v13, v13, v37
    v_add_f32 v61, v61, v85
    v_add_f32 v14, v14, v38
    v_add_f32 v62, v62, v86
    v_add_f32 v15, v15, v39
    v_add_f32 v63, v63, v87
    v_add_f32 v16, v16, v40
    v_add_f32 v64, v64, v88
    v_add_f32 v17, v17, v41
    v_add_f32 v65, v65, v89
    v_add_f32 v18, v18, v42
    v_add_f32 v66, v66, v90
    v_add_f32 v19, v19, v43
    v_add_f32 v67, v67, v91
    v_add_f32 v20, v20, v44
    v_add_f32 v68, v68, v92
    v_add_f32 v21, v21, v45
    v_add_f32 v69, v69, v93
    v_add_f32 v22, v22, v46
    v_add_f32 v70, v70, v94
    v_add_f32 v23, v23, v47
    v_add_f32 v71, v71, v95
    v_add_f32 v24, v24, v48
    v_add_f32 v72, v72, v96
    v_add_f32 v25, v25, v49
    v_add_f32 v73, v73, v97
    v_add_f32 v26, v26, v50
    v_add_f32 v74, v74, v98
    v_add_f32 v27, v27, v51
    v_add_f32 v75, v75, v99
    v_add_f32 v28, v28, v52
    v_add_f32 v76, v76, v100
    v_add_f32 v29, v29, v53
    v_add_f32 v77, v77, v101
    v_add_f32 v30, v30, v54
    v_add_f32 v78, v78, v102
    v_add_f32 v31, v31, v55
    v_add_f32 v79, v79, v103
    v_add_f32 v32, v32, v56
    v_add_f32 v80, v80, v104
    v_add_f32 v33, v33, v57
    v_add_f32 v81, v81, v105
    v_add_f32 v10, v10, v58
    v_add_f32 v11, v11, v59
    v_add_f32 v12, v12, v60
    v_add_f32 v13, v13, v61
    v_add_f32 v14, v14, v62
    v_add_f32 v15, v15, v63
    v_add_f32 v16, v16, v64
    v_add_f32 v17, v17, v65
    v_add_f32 v18, v18, v66
    v_add_f32 v19, v19, v67
    v_add_f32 v20, v20, v68
    v_add_f32 v21, v21, v69
    v_add_f32 v22, v22, v70
    v_add_f32 v23, v23, v71
    v_add_f32 v24, v24, v72
    v_add_f32 v25, v25, v73
    v_add_f32 v26, v26, v74
    v_add_f32 v27, v27, v75
    v_add_f32 v28, v28, v76
    v_add_f32 v29, v29, v77
    v_add_f32 v30, v30, v78
    v_add_f32 v31, v31, v79
    v_add_f32 v32, v32, v80
    v_add_f32 v33, v33, v81
    v_lshlrev_b32 v110, 16, v248
    v_lshlrev_b32 v111, 16, v249
    v_sub_f32 v112, 1.0, v250
    v_sub_f32 v113, 1.0, v251
    v_cvt_pk_bf16_f32 v114, v112, v113
    v_lshlrev_b32 v112, 16, v114
    v_and_b32 v113, 0xffff0000, v114
    v_mul_u32_u24 v6, 0x480, v223
    v_lshl_add_u32 v6, v222, 1, v6
    v_cvt_pk_bf16_f32 v114, v10, v11
    v_lshlrev_b32 v10, 16, v114
    v_and_b32 v11, 0xffff0000, v114
    v_cvt_pk_bf16_f32 v115, v12, v13
    v_lshlrev_b32 v12, 16, v115
    v_and_b32 v13, 0xffff0000, v115
    v_add_f32 v10, v10, v110
    v_add_f32 v11, v11, v110
    v_add_f32 v12, v12, v110
    v_add_f32 v13, v13, v110
    v_cvt_pk_bf16_f32 v114, v10, v11
    v_lshlrev_b32 v10, 16, v114
    v_and_b32 v11, 0xffff0000, v114
    v_cvt_pk_bf16_f32 v115, v12, v13
    v_lshlrev_b32 v12, 16, v115
    v_and_b32 v13, 0xffff0000, v115
    v_mul_f32 v10, v10, v112
    v_lshlrev_b32 v224, 16, v224
    v_mul_f32 v224, v224, v250
    v_mul_f32 v11, v11, v112
    v_lshlrev_b32 v225, 16, v225
    v_mul_f32 v225, v225, v250
    v_mul_f32 v12, v12, v112
    v_lshlrev_b32 v226, 16, v226
    v_mul_f32 v226, v226, v250
    v_mul_f32 v13, v13, v112
    v_lshlrev_b32 v227, 16, v227
    v_mul_f32 v227, v227, v250
    v_cvt_pk_bf16_f32 v114, v10, v11
    v_lshlrev_b32 v10, 16, v114
    v_and_b32 v11, 0xffff0000, v114
    v_cvt_pk_bf16_f32 v115, v12, v13
    v_lshlrev_b32 v12, 16, v115
    v_and_b32 v13, 0xffff0000, v115
    v_cvt_pk_bf16_f32 v114, v224, v225
    v_lshlrev_b32 v224, 16, v114
    v_and_b32 v225, 0xffff0000, v114
    v_cvt_pk_bf16_f32 v115, v226, v227
    v_lshlrev_b32 v226, 16, v115
    v_and_b32 v227, 0xffff0000, v115
    v_add_f32 v10, v10, v224
    v_add_f32 v11, v11, v225
    v_add_f32 v12, v12, v226
    v_add_f32 v13, v13, v227
    v_cvt_pk_bf16_f32 v116, v10, v11
    v_cvt_pk_bf16_f32 v117, v12, v13
    s_mov_b32 s46, 0
    buffer_store_dwordx2 v[116:117], v6, s[28:31], s46 offen offset:0
    s_nop 1
    v_cvt_pk_bf16_f32 v114, v14, v15
    v_lshlrev_b32 v14, 16, v114
    v_and_b32 v15, 0xffff0000, v114
    v_cvt_pk_bf16_f32 v115, v16, v17
    v_lshlrev_b32 v16, 16, v115
    v_and_b32 v17, 0xffff0000, v115
    v_add_f32 v14, v14, v110
    v_add_f32 v15, v15, v110
    v_add_f32 v16, v16, v110
    v_add_f32 v17, v17, v110
    v_cvt_pk_bf16_f32 v114, v14, v15
    v_lshlrev_b32 v14, 16, v114
    v_and_b32 v15, 0xffff0000, v114
    v_cvt_pk_bf16_f32 v115, v16, v17
    v_lshlrev_b32 v16, 16, v115
    v_and_b32 v17, 0xffff0000, v115
    v_mul_f32 v14, v14, v112
    v_lshlrev_b32 v232, 16, v232
    v_mul_f32 v232, v232, v250
    v_mul_f32 v15, v15, v112
    v_lshlrev_b32 v233, 16, v233
    v_mul_f32 v233, v233, v250
    v_mul_f32 v16, v16, v112
    v_lshlrev_b32 v234, 16, v234
    v_mul_f32 v234, v234, v250
    v_mul_f32 v17, v17, v112
    v_lshlrev_b32 v235, 16, v235
    v_mul_f32 v235, v235, v250
    v_cvt_pk_bf16_f32 v114, v14, v15
    v_lshlrev_b32 v14, 16, v114
    v_and_b32 v15, 0xffff0000, v114
    v_cvt_pk_bf16_f32 v115, v16, v17
    v_lshlrev_b32 v16, 16, v115
    v_and_b32 v17, 0xffff0000, v115
    v_cvt_pk_bf16_f32 v114, v232, v233
    v_lshlrev_b32 v232, 16, v114
    v_and_b32 v233, 0xffff0000, v114
    v_cvt_pk_bf16_f32 v115, v234, v235
    v_lshlrev_b32 v234, 16, v115
    v_and_b32 v235, 0xffff0000, v115
    v_add_f32 v14, v14, v232
    v_add_f32 v15, v15, v233
    v_add_f32 v16, v16, v234
    v_add_f32 v17, v17, v235
    v_cvt_pk_bf16_f32 v116, v14, v15
    v_cvt_pk_bf16_f32 v117, v16, v17
    s_mov_b32 s46, 0
    buffer_store_dwordx2 v[116:117], v6, s[28:31], s46 offen offset:64
    s_nop 1
    v_cvt_pk_bf16_f32 v114, v18, v19
    v_lshlrev_b32 v18, 16, v114
    v_and_b32 v19, 0xffff0000, v114
    v_cvt_pk_bf16_f32 v115, v20, v21
    v_lshlrev_b32 v20, 16, v115
    v_and_b32 v21, 0xffff0000, v115
    v_add_f32 v18, v18, v110
    v_add_f32 v19, v19, v110
    v_add_f32 v20, v20, v110
    v_add_f32 v21, v21, v110
    v_cvt_pk_bf16_f32 v114, v18, v19
    v_lshlrev_b32 v18, 16, v114
    v_and_b32 v19, 0xffff0000, v114
    v_cvt_pk_bf16_f32 v115, v20, v21
    v_lshlrev_b32 v20, 16, v115
    v_and_b32 v21, 0xffff0000, v115
    v_mul_f32 v18, v18, v112
    v_lshlrev_b32 v240, 16, v240
    v_mul_f32 v240, v240, v250
    v_mul_f32 v19, v19, v112
    v_lshlrev_b32 v241, 16, v241
    v_mul_f32 v241, v241, v250
    v_mul_f32 v20, v20, v112
    v_lshlrev_b32 v242, 16, v242
    v_mul_f32 v242, v242, v250
    v_mul_f32 v21, v21, v112
    v_lshlrev_b32 v243, 16, v243
    v_mul_f32 v243, v243, v250
    v_cvt_pk_bf16_f32 v114, v18, v19
    v_lshlrev_b32 v18, 16, v114
    v_and_b32 v19, 0xffff0000, v114
    v_cvt_pk_bf16_f32 v115, v20, v21
    v_lshlrev_b32 v20, 16, v115
    v_and_b32 v21, 0xffff0000, v115
    v_cvt_pk_bf16_f32 v114, v240, v241
    v_lshlrev_b32 v240, 16, v114
    v_and_b32 v241, 0xffff0000, v114
    v_cvt_pk_bf16_f32 v115, v242, v243
    v_lshlrev_b32 v242, 16, v115
    v_and_b32 v243, 0xffff0000, v115
    v_add_f32 v18, v18, v240
    v_add_f32 v19, v19, v241
    v_add_f32 v20, v20, v242
    v_add_f32 v21, v21, v243
    v_cvt_pk_bf16_f32 v116, v18, v19
    v_cvt_pk_bf16_f32 v117, v20, v21
    s_mov_b32 s46, 0
    buffer_store_dwordx2 v[116:117], v6, s[28:31], s46 offen offset:128
    s_nop 1
    v_cvt_pk_bf16_f32 v114, v22, v23
    v_lshlrev_b32 v22, 16, v114
    v_and_b32 v23, 0xffff0000, v114
    v_cvt_pk_bf16_f32 v115, v24, v25
    v_lshlrev_b32 v24, 16, v115
    v_and_b32 v25, 0xffff0000, v115
    v_add_f32 v22, v22, v111
    v_add_f32 v23, v23, v111
    v_add_f32 v24, v24, v111
    v_add_f32 v25, v25, v111
    v_cvt_pk_bf16_f32 v114, v22, v23
    v_lshlrev_b32 v22, 16, v114
    v_and_b32 v23, 0xffff0000, v114
    v_cvt_pk_bf16_f32 v115, v24, v25
    v_lshlrev_b32 v24, 16, v115
    v_and_b32 v25, 0xffff0000, v115
    v_mul_f32 v22, v22, v113
    v_lshlrev_b32 v228, 16, v228
    v_mul_f32 v228, v228, v251
    v_mul_f32 v23, v23, v113
    v_lshlrev_b32 v229, 16, v229
    v_mul_f32 v229, v229, v251
    v_mul_f32 v24, v24, v113
    v_lshlrev_b32 v230, 16, v230
    v_mul_f32 v230, v230, v251
    v_mul_f32 v25, v25, v113
    v_lshlrev_b32 v231, 16, v231
    v_mul_f32 v231, v231, v251
    v_cvt_pk_bf16_f32 v114, v22, v23
    v_lshlrev_b32 v22, 16, v114
    v_and_b32 v23, 0xffff0000, v114
    v_cvt_pk_bf16_f32 v115, v24, v25
    v_lshlrev_b32 v24, 16, v115
    v_and_b32 v25, 0xffff0000, v115
    v_cvt_pk_bf16_f32 v114, v228, v229
    v_lshlrev_b32 v228, 16, v114
    v_and_b32 v229, 0xffff0000, v114
    v_cvt_pk_bf16_f32 v115, v230, v231
    v_lshlrev_b32 v230, 16, v115
    v_and_b32 v231, 0xffff0000, v115
    v_add_f32 v22, v22, v228
    v_add_f32 v23, v23, v229
    v_add_f32 v24, v24, v230
    v_add_f32 v25, v25, v231
    v_cvt_pk_bf16_f32 v116, v22, v23
    v_cvt_pk_bf16_f32 v117, v24, v25
    s_mov_b32 s46, 36864
    buffer_store_dwordx2 v[116:117], v6, s[28:31], s46 offen offset:0
    s_nop 1
    v_cvt_pk_bf16_f32 v114, v26, v27
    v_lshlrev_b32 v26, 16, v114
    v_and_b32 v27, 0xffff0000, v114
    v_cvt_pk_bf16_f32 v115, v28, v29
    v_lshlrev_b32 v28, 16, v115
    v_and_b32 v29, 0xffff0000, v115
    v_add_f32 v26, v26, v111
    v_add_f32 v27, v27, v111
    v_add_f32 v28, v28, v111
    v_add_f32 v29, v29, v111
    v_cvt_pk_bf16_f32 v114, v26, v27
    v_lshlrev_b32 v26, 16, v114
    v_and_b32 v27, 0xffff0000, v114
    v_cvt_pk_bf16_f32 v115, v28, v29
    v_lshlrev_b32 v28, 16, v115
    v_and_b32 v29, 0xffff0000, v115
    v_mul_f32 v26, v26, v113
    v_lshlrev_b32 v236, 16, v236
    v_mul_f32 v236, v236, v251
    v_mul_f32 v27, v27, v113
    v_lshlrev_b32 v237, 16, v237
    v_mul_f32 v237, v237, v251
    v_mul_f32 v28, v28, v113
    v_lshlrev_b32 v238, 16, v238
    v_mul_f32 v238, v238, v251
    v_mul_f32 v29, v29, v113
    v_lshlrev_b32 v239, 16, v239
    v_mul_f32 v239, v239, v251
    v_cvt_pk_bf16_f32 v114, v26, v27
    v_lshlrev_b32 v26, 16, v114
    v_and_b32 v27, 0xffff0000, v114
    v_cvt_pk_bf16_f32 v115, v28, v29
    v_lshlrev_b32 v28, 16, v115
    v_and_b32 v29, 0xffff0000, v115
    v_cvt_pk_bf16_f32 v114, v236, v237
    v_lshlrev_b32 v236, 16, v114
    v_and_b32 v237, 0xffff0000, v114
    v_cvt_pk_bf16_f32 v115, v238, v239
    v_lshlrev_b32 v238, 16, v115
    v_and_b32 v239, 0xffff0000, v115
    v_add_f32 v26, v26, v236
    v_add_f32 v27, v27, v237
    v_add_f32 v28, v28, v238
    v_add_f32 v29, v29, v239
    v_cvt_pk_bf16_f32 v116, v26, v27
    v_cvt_pk_bf16_f32 v117, v28, v29
    s_mov_b32 s46, 36864
    buffer_store_dwordx2 v[116:117], v6, s[28:31], s46 offen offset:64
    s_nop 1
    v_cvt_pk_bf16_f32 v114, v30, v31
    v_lshlrev_b32 v30, 16, v114
    v_and_b32 v31, 0xffff0000, v114
    v_cvt_pk_bf16_f32 v115, v32, v33
    v_lshlrev_b32 v32, 16, v115
    v_and_b32 v33, 0xffff0000, v115
    v_add_f32 v30, v30, v111
    v_add_f32 v31, v31, v111
    v_add_f32 v32, v32, v111
    v_add_f32 v33, v33, v111
    v_cvt_pk_bf16_f32 v114, v30, v31
    v_lshlrev_b32 v30, 16, v114
    v_and_b32 v31, 0xffff0000, v114
    v_cvt_pk_bf16_f32 v115, v32, v33
    v_lshlrev_b32 v32, 16, v115
    v_and_b32 v33, 0xffff0000, v115
    v_mul_f32 v30, v30, v113
    v_lshlrev_b32 v244, 16, v244
    v_mul_f32 v244, v244, v251
    v_mul_f32 v31, v31, v113
    v_lshlrev_b32 v245, 16, v245
    v_mul_f32 v245, v245, v251
    v_mul_f32 v32, v32, v113
    v_lshlrev_b32 v246, 16, v246
    v_mul_f32 v246, v246, v251
    v_mul_f32 v33, v33, v113
    v_lshlrev_b32 v247, 16, v247
    v_mul_f32 v247, v247, v251
    v_cvt_pk_bf16_f32 v114, v30, v31
    v_lshlrev_b32 v30, 16, v114
    v_and_b32 v31, 0xffff0000, v114
    v_cvt_pk_bf16_f32 v115, v32, v33
    v_lshlrev_b32 v32, 16, v115
    v_and_b32 v33, 0xffff0000, v115
    v_cvt_pk_bf16_f32 v114, v244, v245
    v_lshlrev_b32 v244, 16, v114
    v_and_b32 v245, 0xffff0000, v114
    v_cvt_pk_bf16_f32 v115, v246, v247
    v_lshlrev_b32 v246, 16, v115
    v_and_b32 v247, 0xffff0000, v115
    v_add_f32 v30, v30, v244
    v_add_f32 v31, v31, v245
    v_add_f32 v32, v32, v246
    v_add_f32 v33, v33, v247
    v_cvt_pk_bf16_f32 v116, v30, v31
    v_cvt_pk_bf16_f32 v117, v32, v33
    s_mov_b32 s46, 36864
    buffer_store_dwordx2 v[116:117], v6, s[28:31], s46 offen offset:128
    s_nop 1
L_g2_done:
    s_endpgm
.section .rodata,"a"
.p2align 6
.amdhsa_kernel gemm2_kernel
  .amdhsa_next_free_vgpr 256
  .amdhsa_next_free_sgpr 102
  .amdhsa_accum_offset 256
  .amdhsa_group_segment_fixed_size 0
  .amdhsa_kernarg_size 128
  .amdhsa_user_sgpr_count 2
  .amdhsa_user_sgpr_kernarg_segment_ptr 1
  .amdhsa_system_sgpr_workgroup_id_x 1
.end_amdhsa_kernel
```
